```python
import torch

def _softmax(x, axis=-1):
    return torch.softmax(x, dim=axis)
def _gelu(x):
    return torch.nn.functional.gelu(x, approximate="tanh")
def _silu(x):
    return torch.nn.functional.silu(x)
def _sigmoid(x):
    return torch.sigmoid(x)
def _layernorm(x, axis=-1, eps=1e-5):
    m = x.mean(dim=axis, keepdim=True)
    v = x.var(dim=axis, keepdim=True, unbiased=False)
    return (x - m) / torch.sqrt(v + eps)
def _scatter_add(tgt, idx, src, axis=0):
    return tgt.clone().index_add_(axis, idx, src)
def _segment_sum(src, seg, n):
    out = torch.zeros((n,) + src.shape[1:], dtype=src.dtype)
    return out.index_add_(0, seg, src)
def _pad(x, pw):
    flat = tuple(v for pair in reversed(pw) for v in pair)
    return torch.nn.functional.pad(x, flat)

kernel_name = 'recurrent_scan__gqa_block_cached__dense_activation_squared_relu__decode'

def setup_inputs():

    _w = (lambda a: (lambda t: t.to(torch.bfloat16) if t.is_floating_point() else t)(torch.as_tensor(a)))
    def _A_setup():
        B, Sq, D = 2, 1, 640
        Hq, Hkv, Sk, Dh = 32, 32, 8192, 192
        assert Hq % Hkv == 0, (Hq, Hkv)
        return {
            "x": _w((lambda *s: torch.randn(*s, dtype=torch.bfloat16) * 0.05)(B, Sq, D)),
            "k_cache": _w((lambda *s: torch.randn(*s, dtype=torch.bfloat16) * 1.6)(B, Hkv, Sk, Dh)),
            "v_cache": _w((lambda *s: torch.randn(*s, dtype=torch.bfloat16) * 0.2)(B, Hkv, Sk, Dh)),
            "wq": _w((lambda *s: torch.randn(*s, dtype=torch.bfloat16) * 1.6)(D, Hq * Dh) * (D ** -0.5)),
            "wo": _w((lambda *s: torch.randn(*s, dtype=torch.bfloat16) * 0.2)(Hq * Dh, D) * ((Hq * Dh) ** -0.5)),
        }
    _A_in = _A_setup()

    def _B_setup():
        B, S, D, F = 2, 1, 640, 1536
        return {
            "x": _w((lambda *s: torch.randn(*s, dtype=torch.bfloat16) * 0.05)(B, S, D)),
            "w1": _w((lambda *s: torch.randn(*s, dtype=torch.bfloat16) * 0.1)(D, F)),
            "b1": _w((lambda *s: torch.randn(*s, dtype=torch.bfloat16) * 0.1)(F)),
            "w2": _w((lambda *s: torch.randn(*s, dtype=torch.bfloat16) * 0.1)(F, D)),
            "b2": _w((lambda *s: torch.randn(*s, dtype=torch.bfloat16) * 0.1)(D)),
        }
    _B_in = _B_setup()

    return {
        "A_x": _A_in["x"],
        "A_k_cache": _A_in["k_cache"],
        "A_v_cache": _A_in["v_cache"],
        "A_wq": _A_in["wq"],
        "A_wo": _A_in["wo"],
        "B_x": _B_in["x"],
        "B_w1": _B_in["w1"],
        "B_b1": _B_in["b1"],
        "B_w2": _B_in["w2"],
        "B_b2": _B_in["b2"],
    }

def reference(A_x, A_k_cache, A_v_cache, A_wq, A_wo, B_x, B_w1, B_b1, B_w2, B_b2):
    def _A_ref(x, k_cache, v_cache, wq, wo):
        B, Sq, D = x.shape
        Hq, Dh = 32, 192
        Hkv = k_cache.shape[1]
        rep = Hq // Hkv
        q = (lambda x, *d: x.permute(*d))((x @ wq).reshape(B, Sq, Hq, Dh), 0, 2, 1, 3)
        k = (lambda x, n, axis: torch.repeat_interleave(x, n, dim=axis))(k_cache, rep, axis=1)
        v = (lambda x, n, axis: torch.repeat_interleave(x, n, dim=axis))(v_cache, rep, axis=1)
        scores = torch.einsum("bhqd,bhkd->bhqk", q, k) * (Dh ** -0.5)
        p = _softmax(scores, axis=-1)
        o = torch.einsum("bhqk,bhkd->bhqd", p, v)
        return (lambda x, *d: x.permute(*d))(o, 0, 2, 1, 3).reshape(B, Sq, Hq * Dh) @ wo

    def _B_ref(x, w1, b1, w2, b2):
        h = torch.einsum("bsd,df->bsf", x, w1) + b1
        zero = torch.zeros_like(h)
        r = torch.where(h > zero, h, zero)
        h = r * r
        out = torch.einsum("bsf,fd->bsd", h, w2) + b2
        return out

    x = A_x
    xn = _layernorm(x, axis=-1)
    s = _A_ref(xn, A_k_cache, A_v_cache, A_wq, A_wo)
    g = _silu(_B_ref(xn, B_w1, B_b1, B_w2, B_b2))
    return x + s * g
```

```asm
; @launch grid=(256,1,1) block=(512,1,1) lds=54848
.amdgcn_target "amdgcn-amd-amdhsa--gfx950"
.text
.globl recurrent_scan__gqa_block_cached__dense_activation_squared_relu__decode_kernel
.p2align 8
.type recurrent_scan__gqa_block_cached__dense_activation_squared_relu__decode_kernel,@function
recurrent_scan__gqa_block_cached__dense_activation_squared_relu__decode_kernel:
    s_cmp_ge_u32 s2, 256
    s_cbranch_scc1 LA_done
    s_load_dwordx16 s[16:31], s[0:1], 0
    s_load_dwordx8 s[32:39], s[0:1], 64
    s_load_dwordx2 s[40:41], s[0:1], 96
    v_lshrrev_b32 v9, 6, v0
    v_and_b32 v1, 63, v0
    v_readfirstlane_b32 s3, v9
    s_and_b32 s80, s2, 7
    s_lshr_b32 s81, s2, 3
    s_lshr_b32 s82, s81, 3
    s_lshl2_add_u32 s4, s80, s82
    s_mov_b32 s5, s4
    s_and_b32 s83, s81, 7
    s_cmp_ge_u32 s83, 3
    s_cselect_b32 s42, 1, 0
    s_mul_i32 s43, s42, 3
    s_sub_u32 s43, s83, s43
    s_mul_i32 s100, s5, 3
    s_add_u32 s43, s43, s100
    s_mul_i32 s100, s80, 3
    s_add_u32 s100, s100, s82
    s_sub_u32 s101, s83, 6
    s_cmp_eq_u32 s82, 3
    s_cselect_b32 s12, 0, 980096
    s_movk_i32 s10, 3072
    s_cmp_lt_u32 s83, 6
    s_cselect_b32 s42, s42, s101
    s_cselect_b32 s43, s43, s100
    s_cselect_b32 s10, 12288, s10
    s_cselect_b32 s54, 3920000, s12
    s_mul_i32 s11, s42, 320
    s_mul_i32 s42, s11, s10
    s_mul_i32 s43, s43, 128
    v_lshrrev_b32 v9, 3, v0
    v_and_b32 v10, 7, v1
    v_lshlrev_b32 v10, 4, v10
    v_mul_u32_u24 v3, s10, v9
    v_add_u32 v3, v3, v10
    s_mul_i32 s12, s3, 1280
    v_mul_u32_u24 v11, 20, v1
    v_add_u32 v11, s12, v11
    s_mul_i32 s10, s10, 64
    s_waitcnt lgkmcnt(0)
    s_cselect_b32 s100, s22, s28
    s_cselect_b32 s101, s23, s29
    s_mov_b32 s60, s16
    s_mov_b32 s61, s17
    s_mov_b32 s62, 2560
    s_mov_b32 s63, 0x20000
    buffer_load_dwordx4 v[12:15], v11, s[60:63], 0 offen
    buffer_load_dword v8, v11, s[60:63], 0 offen offset:16
    s_add_u32 s42, s42, s43
    s_add_u32 s52, s100, s42
    s_addc_u32 s53, s101, 0
    s_mov_b32 s55, 0x20000
    buffer_load_dwordx4 v[52:55], v3, s[52:55], 0 offen nt
    buffer_load_dwordx4 v[56:59], v3, s[52:55], s10 offen nt
    s_mul_i32 s12, s10, 2
    buffer_load_dwordx4 v[60:63], v3, s[52:55], s12 offen nt
    s_mul_i32 s12, s10, 3
    buffer_load_dwordx4 v[64:67], v3, s[52:55], s12 offen nt
    s_mul_i32 s12, s10, 4
    buffer_load_dwordx4 v[68:71], v3, s[52:55], s12 offen nt
    s_load_dword s75, s[40:41], 0
    s_and_b32 s6, s81, 7
    s_lshl_b32 s7, s80, 5
    s_add_u32 s7, s7, s81
    s_mul_i32 s8, s4, 3145728
    v_lshrrev_b32 v9, 3, v1
    v_mul_u32_u24 v2, 384, v9
    v_add_u32 v2, v2, v10
    s_lshl3_add_u32 s9, s6, s3
    s_lshr_b32 s82, s4, 3
    s_mul_i32 s82, s82, 85
    s_add_u32 s9, s9, s82
    s_mul_i32 s9, s9, 3072
    s_add_u32 s9, s9, s8
    s_add_u32 s8, s8, 3145728
    s_mov_b32 s44, s18
    s_mov_b32 s45, s19
    s_mov_b32 s46, 201326592
    s_mov_b32 s47, 0x20000
    s_mov_b32 s48, s20
    s_mov_b32 s49, s21
    s_mov_b32 s50, 201326592
    s_mov_b32 s51, 0x20000
    s_sub_u32 s81, 31, s81
    s_mul_i32 s82, s81, 26
    s_lshr_b32 s82, s82, 8
    s_mul_i32 s83, s82, 10
    s_sub_u32 s83, s81, s83
    s_mul_i32 s74, s80, 3
    s_add_u32 s74, s74, s82
    s_mul_i32 s81, s74, 81920
    s_lshl_b32 s100, s83, 7
    s_add_u32 s81, s81, s100
    s_mul_i32 s26, s83, 24
    s_add_u32 s26, s26, s74
    s_lshl_b32 s26, s26, 9
    s_add_u32 s26, s26, 196608
    s_lshl2_add_u32 s27, s80, s82
    s_lshl_b32 s27, s27, 12
    s_add_u32 s27, s27, 68608
    s_cmp_lt_u32 s82, 3
    s_cselect_b32 s81, s81, 0
    s_cselect_b32 s100, 80768, 0
    s_cselect_b32 s26, s26, 1073741824
    s_cselect_b32 s74, s74, 99
    s_add_u32 s68, s32, s81
    s_addc_u32 s69, s33, 0
    s_mov_b32 s70, s100
    s_mov_b32 s71, 0x20000
    s_mul_i32 s81, s4, 245760
    s_mul_i32 s12, s3, 10240
    s_add_u32 s56, s24, s81
    s_addc_u32 s57, s25, 0
    s_mov_b32 s58, 245760
    s_mov_b32 s59, 0x20000
    s_mov_b32 s64, s30
    s_mov_b32 s65, s31
    s_mov_b32 s66, 3072
    s_mov_b32 s67, 0x20000
    s_mov_b32 s76, s40
    s_mov_b32 s77, s41
    s_mov_b32 s78, 2097152
    s_mov_b32 s79, 0x20000
    s_mov_b32 s13, 0xffff0000
    s_mov_b32 s14, 0x3d93cd3a
    s_mov_b32 s15, 0x3fb8aa3b
    s_mov_b32 s72, 0x0c0c0400
    s_mov_b32 s73, 0xffffff00
    s_cmp_lt_u32 s2, 80
    s_cselect_b32 s100, 1, 0
    s_cmp_ge_u32 s2, 40
    s_cselect_b32 s42, 1, 0
    s_mul_i32 s43, s42, 40
    s_sub_u32 s43, s2, s43
    s_lshl_b32 s43, s43, 6
    v_lshlrev_b32 v4, 4, v1
    v_lshlrev_b32 v5, 2, v1
    s_mov_b32 s20, 0x05040100
    s_mov_b32 s21, 0x07060302
    v_mov_b32 v7, 0xff800000
    s_mov_b32 s32, 1
    s_lshr_b32 s38, s7, 5
    s_lshl_b32 s38, s38, 6
    s_and_b32 s39, s7, 31
    s_add_u32 s39, s39, s38
    s_lshl_b32 s39, s39, 2
    s_add_u32 s39, s39, 0xA000
    s_cmp_eq_u32 s3, 0
    s_cselect_b32 s39, s39, 1073741824
    s_mov_b32 s38, 1
    v_mov_b32 v16, 0
    v_mov_b32 v17, 0
    v_mov_b32 v18, 0
    v_mov_b32 v19, 0
    v_mov_b32 v20, 0
    v_mov_b32 v21, 0
    v_mov_b32 v22, 0
    v_mov_b32 v23, 0
    v_mov_b32 v24, 0
    v_mov_b32 v25, 0
    v_mov_b32 v26, 0
    v_mov_b32 v27, 0
    v_mov_b32 v28, 0
    v_mov_b32 v29, 0
    v_mov_b32 v30, 0
    v_mov_b32 v31, 0
    s_cmp_ge_u32 s3, 2
    s_cbranch_scc1 Lln
    s_waitcnt vmcnt(5)
    v_lshlrev_b32 v40, 16, v12
    v_and_b32 v41, s13, v12
    v_lshlrev_b32 v42, 16, v13
    v_and_b32 v43, s13, v13
    v_lshlrev_b32 v44, 16, v14
    v_and_b32 v45, s13, v14
    v_lshlrev_b32 v46, 16, v15
    v_and_b32 v47, s13, v15
    v_lshlrev_b32 v48, 16, v8
    v_and_b32 v49, s13, v8
    v_add_f32 v9, v40, v41
    v_add_f32 v9, v9, v42
    v_add_f32 v9, v9, v43
    v_add_f32 v9, v9, v44
    v_add_f32 v9, v9, v45
    v_add_f32 v9, v9, v46
    v_add_f32 v9, v9, v47
    v_add_f32 v9, v9, v48
    v_add_f32 v9, v9, v49
    s_nop 1
    v_add_f32_dpp v9, v9, v9 quad_perm:[1,0,3,2] row_mask:0xf bank_mask:0xf
    s_nop 1
    v_add_f32_dpp v9, v9, v9 quad_perm:[2,3,0,1] row_mask:0xf bank_mask:0xf
    s_nop 1
    v_add_f32_dpp v9, v9, v9 row_half_mirror row_mask:0xf bank_mask:0xf
    s_nop 1
    v_add_f32_dpp v9, v9, v9 row_mirror row_mask:0xf bank_mask:0xf
    v_mov_b32 v10, v9
    s_nop 1
    v_permlane16_swap_b32 v9, v10
    v_add_f32 v9, v9, v10
    v_mov_b32 v10, v9
    s_nop 1
    v_permlane32_swap_b32 v9, v10
    v_add_f32 v9, v9, v10
    v_mul_f32 v9, 0x3acccccd, v9
    v_mov_b32 v12, 0
    v_sub_f32 v13, v40, v9
    v_fmac_f32 v12, v13, v13
    v_sub_f32 v13, v41, v9
    v_fmac_f32 v12, v13, v13
    v_sub_f32 v13, v42, v9
    v_fmac_f32 v12, v13, v13
    v_sub_f32 v13, v43, v9
    v_fmac_f32 v12, v13, v13
    v_sub_f32 v13, v44, v9
    v_fmac_f32 v12, v13, v13
    v_sub_f32 v13, v45, v9
    v_fmac_f32 v12, v13, v13
    v_sub_f32 v13, v46, v9
    v_fmac_f32 v12, v13, v13
    v_sub_f32 v13, v47, v9
    v_fmac_f32 v12, v13, v13
    v_sub_f32 v13, v48, v9
    v_fmac_f32 v12, v13, v13
    v_sub_f32 v13, v49, v9
    v_fmac_f32 v12, v13, v13
    s_nop 1
    v_add_f32_dpp v12, v12, v12 quad_perm:[1,0,3,2] row_mask:0xf bank_mask:0xf
    s_nop 1
    v_add_f32_dpp v12, v12, v12 quad_perm:[2,3,0,1] row_mask:0xf bank_mask:0xf
    s_nop 1
    v_add_f32_dpp v12, v12, v12 row_half_mirror row_mask:0xf bank_mask:0xf
    s_nop 1
    v_add_f32_dpp v12, v12, v12 row_mirror row_mask:0xf bank_mask:0xf
    v_mov_b32 v10, v12
    s_nop 1
    v_permlane16_swap_b32 v12, v10
    v_add_f32 v12, v12, v10
    v_mov_b32 v10, v12
    s_nop 1
    v_permlane32_swap_b32 v12, v10
    v_add_f32 v12, v12, v10
    v_mul_f32 v12, 0x3acccccd, v12
    v_cvt_pk_bf16_f32 v9, v9, v12
    v_and_b32 v12, s13, v9
    v_lshlrev_b32 v9, 16, v9
    v_add_f32 v12, 0x3727c5ac, v12
    v_cvt_pk_bf16_f32 v12, v12, v12
    v_and_b32 v12, s13, v12
    v_sqrt_f32 v12, v12
    s_nop 0
    v_cvt_pk_bf16_f32 v12, v12, v12
    v_and_b32 v12, s13, v12
    v_rcp_f32 v13, v12
    v_sub_f32 v40, v40, v9
    v_sub_f32 v41, v41, v9
    v_sub_f32 v42, v42, v9
    v_sub_f32 v43, v43, v9
    v_sub_f32 v44, v44, v9
    v_sub_f32 v45, v45, v9
    v_sub_f32 v46, v46, v9
    v_sub_f32 v47, v47, v9
    v_sub_f32 v48, v48, v9
    v_sub_f32 v49, v49, v9
    v_cvt_pk_bf16_f32 v41, v40, v41
    v_lshlrev_b32 v40, 16, v41
    v_and_b32 v41, s13, v41
    v_mul_f32 v14, v40, v13
    v_fma_f32 v15, -v14, v12, v40
    v_fma_f32 v40, v15, v13, v14
    v_mul_f32 v14, v41, v13
    v_fma_f32 v15, -v14, v12, v41
    v_fma_f32 v41, v15, v13, v14
    v_cvt_pk_bf16_f32 v40, v40, v41
    ds_write_b32 v11, v40 offset:0
    v_cvt_pk_bf16_f32 v43, v42, v43
    v_lshlrev_b32 v42, 16, v43
    v_and_b32 v43, s13, v43
    v_mul_f32 v14, v42, v13
    v_fma_f32 v15, -v14, v12, v42
    v_fma_f32 v42, v15, v13, v14
    v_mul_f32 v14, v43, v13
    v_fma_f32 v15, -v14, v12, v43
    v_fma_f32 v43, v15, v13, v14
    v_cvt_pk_bf16_f32 v42, v42, v43
    ds_write_b32 v11, v42 offset:4
    v_cvt_pk_bf16_f32 v45, v44, v45
    v_lshlrev_b32 v44, 16, v45
    v_and_b32 v45, s13, v45
    v_mul_f32 v14, v44, v13
    v_fma_f32 v15, -v14, v12, v44
    v_fma_f32 v44, v15, v13, v14
    v_mul_f32 v14, v45, v13
    v_fma_f32 v15, -v14, v12, v45
    v_fma_f32 v45, v15, v13, v14
    v_cvt_pk_bf16_f32 v44, v44, v45
    ds_write_b32 v11, v44 offset:8
    v_cvt_pk_bf16_f32 v47, v46, v47
    v_lshlrev_b32 v46, 16, v47
    v_and_b32 v47, s13, v47
    v_mul_f32 v14, v46, v13
    v_fma_f32 v15, -v14, v12, v46
    v_fma_f32 v46, v15, v13, v14
    v_mul_f32 v14, v47, v13
    v_fma_f32 v15, -v14, v12, v47
    v_fma_f32 v47, v15, v13, v14
    v_cvt_pk_bf16_f32 v46, v46, v47
    ds_write_b32 v11, v46 offset:12
    v_cvt_pk_bf16_f32 v49, v48, v49
    v_lshlrev_b32 v48, 16, v49
    v_and_b32 v49, s13, v49
    v_mul_f32 v14, v48, v13
    v_fma_f32 v15, -v14, v12, v48
    v_fma_f32 v48, v15, v13, v14
    v_mul_f32 v14, v49, v13
    v_fma_f32 v15, -v14, v12, v49
    v_fma_f32 v49, v15, v13, v14
    v_cvt_pk_bf16_f32 v48, v48, v49
    ds_write_b32 v11, v48 offset:16
Lln:
    v_lshrrev_b32 v9, 3, v0
    v_add_u32 v9, s11, v9
    v_lshlrev_b32 v9, 1, v9
    s_waitcnt lgkmcnt(0)
    s_barrier
    ds_read_u16 v40, v9 offset:0
    ds_read_u16 v41, v9 offset:1280
    ds_read_u16 v42, v9 offset:128
    ds_read_u16 v43, v9 offset:1408
    ds_read_u16 v44, v9 offset:256
    ds_read_u16 v45, v9 offset:1536
    ds_read_u16 v46, v9 offset:384
    ds_read_u16 v47, v9 offset:1664
    ds_read_u16 v48, v9 offset:512
    ds_read_u16 v49, v9 offset:1792
    s_and_b32 s80, s75, 0x7f7f7f7f
    s_add_u32 s80, s80, 0x01010101
    s_and_b32 s75, s75, 0x80808080
    s_xor_b32 s75, s75, s80
    s_add_u32 s10, s9, 0
    s_cmp_ge_u32 s10, s8
    s_cselect_b32 s83, 3145728, 0
    s_sub_u32 s10, s10, s83
    buffer_load_dwordx4 v[84:87], v2, s[44:47], s10 offen offset:0 nt
    buffer_load_dwordx4 v[88:91], v2, s[44:47], s10 offen offset:128 nt
    buffer_load_dwordx4 v[92:95], v2, s[44:47], s10 offen offset:256 nt
    s_add_u32 s10, s9, 196608
    s_cmp_ge_u32 s10, s8
    s_cselect_b32 s83, 3145728, 0
    s_sub_u32 s10, s10, s83
    buffer_load_dwordx4 v[96:99], v2, s[44:47], s10 offen offset:0 nt
    buffer_load_dwordx4 v[100:103], v2, s[44:47], s10 offen offset:128 nt
    buffer_load_dwordx4 v[104:107], v2, s[44:47], s10 offen offset:256 nt
    s_waitcnt lgkmcnt(0)
    s_waitcnt vmcnt(10)
    v_lshlrev_b32 v9, 16, v40
    v_lshlrev_b32 v10, 16, v41
    v_dot2c_f32_bf16 v16, v52, v40
    v_dot2c_f32_bf16 v17, v52, v9
    v_dot2c_f32_bf16 v18, v53, v40
    v_dot2c_f32_bf16 v19, v53, v9
    v_dot2c_f32_bf16 v20, v54, v40
    v_dot2c_f32_bf16 v21, v54, v9
    v_dot2c_f32_bf16 v22, v55, v40
    v_dot2c_f32_bf16 v23, v55, v9
    v_dot2c_f32_bf16 v24, v52, v41
    v_dot2c_f32_bf16 v25, v52, v10
    v_dot2c_f32_bf16 v26, v53, v41
    v_dot2c_f32_bf16 v27, v53, v10
    v_dot2c_f32_bf16 v28, v54, v41
    v_dot2c_f32_bf16 v29, v54, v10
    v_dot2c_f32_bf16 v30, v55, v41
    v_dot2c_f32_bf16 v31, v55, v10
    s_waitcnt vmcnt(9)
    v_lshlrev_b32 v9, 16, v42
    v_lshlrev_b32 v10, 16, v43
    v_dot2c_f32_bf16 v16, v56, v42
    v_dot2c_f32_bf16 v17, v56, v9
    v_dot2c_f32_bf16 v18, v57, v42
    v_dot2c_f32_bf16 v19, v57, v9
    v_dot2c_f32_bf16 v20, v58, v42
    v_dot2c_f32_bf16 v21, v58, v9
    v_dot2c_f32_bf16 v22, v59, v42
    v_dot2c_f32_bf16 v23, v59, v9
    v_dot2c_f32_bf16 v24, v56, v43
    v_dot2c_f32_bf16 v25, v56, v10
    v_dot2c_f32_bf16 v26, v57, v43
    v_dot2c_f32_bf16 v27, v57, v10
    v_dot2c_f32_bf16 v28, v58, v43
    v_dot2c_f32_bf16 v29, v58, v10
    v_dot2c_f32_bf16 v30, v59, v43
    v_dot2c_f32_bf16 v31, v59, v10
    s_waitcnt vmcnt(8)
    v_lshlrev_b32 v9, 16, v44
    v_lshlrev_b32 v10, 16, v45
    v_dot2c_f32_bf16 v16, v60, v44
    v_dot2c_f32_bf16 v17, v60, v9
    v_dot2c_f32_bf16 v18, v61, v44
    v_dot2c_f32_bf16 v19, v61, v9
    v_dot2c_f32_bf16 v20, v62, v44
    v_dot2c_f32_bf16 v21, v62, v9
    v_dot2c_f32_bf16 v22, v63, v44
    v_dot2c_f32_bf16 v23, v63, v9
    v_dot2c_f32_bf16 v24, v60, v45
    v_dot2c_f32_bf16 v25, v60, v10
    v_dot2c_f32_bf16 v26, v61, v45
    v_dot2c_f32_bf16 v27, v61, v10
    v_dot2c_f32_bf16 v28, v62, v45
    v_dot2c_f32_bf16 v29, v62, v10
    v_dot2c_f32_bf16 v30, v63, v45
    v_dot2c_f32_bf16 v31, v63, v10
    s_waitcnt vmcnt(7)
    v_lshlrev_b32 v9, 16, v46
    v_lshlrev_b32 v10, 16, v47
    v_dot2c_f32_bf16 v16, v64, v46
    v_dot2c_f32_bf16 v17, v64, v9
    v_dot2c_f32_bf16 v18, v65, v46
    v_dot2c_f32_bf16 v19, v65, v9
    v_dot2c_f32_bf16 v20, v66, v46
    v_dot2c_f32_bf16 v21, v66, v9
    v_dot2c_f32_bf16 v22, v67, v46
    v_dot2c_f32_bf16 v23, v67, v9
    v_dot2c_f32_bf16 v24, v64, v47
    v_dot2c_f32_bf16 v25, v64, v10
    v_dot2c_f32_bf16 v26, v65, v47
    v_dot2c_f32_bf16 v27, v65, v10
    v_dot2c_f32_bf16 v28, v66, v47
    v_dot2c_f32_bf16 v29, v66, v10
    v_dot2c_f32_bf16 v30, v67, v47
    v_dot2c_f32_bf16 v31, v67, v10
    s_waitcnt vmcnt(6)
    v_lshlrev_b32 v9, 16, v48
    v_lshlrev_b32 v10, 16, v49
    v_dot2c_f32_bf16 v16, v68, v48
    v_dot2c_f32_bf16 v17, v68, v9
    v_dot2c_f32_bf16 v18, v69, v48
    v_dot2c_f32_bf16 v19, v69, v9
    v_dot2c_f32_bf16 v20, v70, v48
    v_dot2c_f32_bf16 v21, v70, v9
    v_dot2c_f32_bf16 v22, v71, v48
    v_dot2c_f32_bf16 v23, v71, v9
    v_dot2c_f32_bf16 v24, v68, v49
    v_dot2c_f32_bf16 v25, v68, v10
    v_dot2c_f32_bf16 v26, v69, v49
    v_dot2c_f32_bf16 v27, v69, v10
    v_dot2c_f32_bf16 v28, v70, v49
    v_dot2c_f32_bf16 v29, v70, v10
    v_dot2c_f32_bf16 v30, v71, v49
    v_dot2c_f32_bf16 v31, v71, v10
    v_and_b32 v11, 7, v1
    v_lshlrev_b32 v11, 5, v11
    s_lshl_b32 s80, s3, 9
    v_add_u32 v11, s80, v11
    v_bfe_u32 v9, v1, 5, 1
    v_lshl_add_u32 v11, v9, 8, v11
    v_bfe_u32 v9, v1, 3, 2
    v_lshl_add_u32 v11, v9, 3, v11
    v_permlane32_swap_b32 v16, v24
    v_permlane32_swap_b32 v17, v25
    v_permlane32_swap_b32 v18, v26
    v_permlane32_swap_b32 v19, v27
    v_permlane32_swap_b32 v20, v28
    v_permlane32_swap_b32 v21, v29
    v_permlane32_swap_b32 v22, v30
    v_permlane32_swap_b32 v23, v31
    v_add_f32 v16, v16, v24
    v_add_f32 v17, v17, v25
    v_add_f32 v18, v18, v26
    v_add_f32 v19, v19, v27
    v_add_f32 v20, v20, v28
    v_add_f32 v21, v21, v29
    v_add_f32 v22, v22, v30
    v_add_f32 v23, v23, v31
    v_permlane16_swap_b32 v16, v20
    v_permlane16_swap_b32 v17, v21
    v_permlane16_swap_b32 v18, v22
    v_permlane16_swap_b32 v19, v23
    v_add_f32 v16, v16, v20
    v_add_f32 v17, v17, v21
    v_add_f32 v18, v18, v22
    v_add_f32 v19, v19, v23
    v_add_f32_dpp v20, v16, v16 row_ror:8 row_mask:0xf bank_mask:0x3
    v_add_f32_dpp v21, v17, v17 row_ror:8 row_mask:0xf bank_mask:0x3
    s_nop 0
    v_add_f32_dpp v20, v18, v18 row_ror:8 row_mask:0xf bank_mask:0xc
    v_add_f32_dpp v21, v19, v19 row_ror:8 row_mask:0xf bank_mask:0xc
    ds_write_b64 v11, v[20:21] offset:2560
    s_lshl_b32 s81, s7, 9
    s_add_u32 s81, s81, 65536
    s_cmp_eq_u32 s3, 0
    s_cselect_b32 s81, s81, 1073741824
    s_waitcnt lgkmcnt(0)
    s_barrier
    v_and_b32 v10, 31, v1
    v_lshlrev_b32 v10, 4, v10
    v_bfe_u32 v9, v1, 5, 1
    v_lshl_add_u32 v9, v9, 11, v10
    ds_read_b128 v[16:19], v9 offset:2560
    ds_read_b128 v[20:23], v9 offset:3072
    ds_read_b128 v[24:27], v9 offset:3584
    ds_read_b128 v[28:31], v9 offset:4096
    s_waitcnt lgkmcnt(0)
    v_add_f32 v16, v16, v24
    v_add_f32 v17, v17, v25
    v_add_f32 v18, v18, v26
    v_add_f32 v19, v19, v27
    v_add_f32 v20, v20, v28
    v_add_f32 v21, v21, v29
    v_add_f32 v22, v22, v30
    v_add_f32 v23, v23, v31
    v_add_f32 v16, v16, v20
    v_add_f32 v17, v17, v21
    v_add_f32 v18, v18, v22
    v_add_f32 v19, v19, v23
    v_mov_b32 v20, v16
    v_mov_b32 v21, v17
    v_mov_b32 v22, v18
    v_mov_b32 v23, v19
    v_permlane32_swap_b32 v16, v20
    v_permlane32_swap_b32 v17, v21
    v_permlane32_swap_b32 v18, v22
    v_permlane32_swap_b32 v19, v23
    v_add_f32 v16, v16, v20
    v_add_f32 v17, v17, v21
    v_add_f32 v18, v18, v22
    v_add_f32 v19, v19, v23
    v_mov_b32_sdwa v16, s75 dst_sel:BYTE_0 dst_unused:UNUSED_PRESERVE src0_sel:BYTE_0
    v_mov_b32_sdwa v17, s75 dst_sel:BYTE_0 dst_unused:UNUSED_PRESERVE src0_sel:BYTE_1
    v_mov_b32_sdwa v18, s75 dst_sel:BYTE_0 dst_unused:UNUSED_PRESERVE src0_sel:BYTE_2
    v_mov_b32_sdwa v19, s75 dst_sel:BYTE_0 dst_unused:UNUSED_PRESERVE src0_sel:BYTE_3
    s_mov_b64 exec, 0xffffffff
    s_cmp_lt_u32 s6, 6
    s_cbranch_scc0 Lpx_far
    buffer_store_dwordx4 v[16:19], v10, s[76:79], s81 offen
Lpx_back:
    s_mov_b64 exec, -1
    s_nop 0
    v_lshrrev_b32 v9, 3, v0
    v_mul_u32_u24 v9, 1280, v9
    v_and_b32 v10, 7, v1
    v_lshl_add_u32 v9, v10, 4, v9
    buffer_load_dwordx4 v[80:83], v9, s[68:71], 0 offen nt
    v_and_b32 v9, 15, v1
    v_lshlrev_b32 v9, 3, v9
    v_lshrrev_b32 v10, 5, v1
    v_lshl_add_u32 v47, v10, 2, v9
    s_lshl_b32 s80, s74, 7
    buffer_load_dword v79, v47, s[64:67], s80 offen
    s_cmp_eq_u32 s42, 0
    s_movk_i32 s80, 5120
    s_cselect_b32 s80, 40960, s80
    v_lshrrev_b32 v9, 2, v0
    v_mul_u32_u24 v9, s80, v9
    v_and_b32 v0, 3, v0
    v_lshl_add_u32 v0, v0, 4, v9
    s_add_u32 s10, s9, 393216
    s_cmp_ge_u32 s10, s8
    s_cselect_b32 s83, 3145728, 0
    s_sub_u32 s10, s10, s83
    s_waitcnt vmcnt(6)
    buffer_load_dwordx4 v[108:111], v2, s[44:47], s10 offen offset:0 nt
    s_waitcnt vmcnt(6)
    buffer_load_dwordx4 v[112:115], v2, s[44:47], s10 offen offset:128 nt
    s_waitcnt vmcnt(6)
    buffer_load_dwordx4 v[116:119], v2, s[44:47], s10 offen offset:256 nt
    s_add_u32 s10, s9, 589824
    s_cmp_ge_u32 s10, s8
    s_cselect_b32 s83, 3145728, 0
    s_sub_u32 s10, s10, s83
    s_waitcnt vmcnt(6)
    buffer_load_dwordx4 v[120:123], v2, s[44:47], s10 offen offset:0 nt
    s_waitcnt vmcnt(3)
    buffer_load_dwordx4 v[124:127], v2, s[44:47], s10 offen offset:128 nt
    s_waitcnt vmcnt(3)
    buffer_load_dwordx4 v[128:131], v2, s[44:47], s10 offen offset:256 nt
    s_add_u32 s10, s9, 786432
    s_cmp_ge_u32 s10, s8
    s_cselect_b32 s83, 3145728, 0
    s_sub_u32 s10, s10, s83
    s_waitcnt vmcnt(3)
    buffer_load_dwordx4 v[132:135], v2, s[44:47], s10 offen offset:0 nt
    s_waitcnt vmcnt(3)
    buffer_load_dwordx4 v[136:139], v2, s[44:47], s10 offen offset:128 nt
    s_waitcnt vmcnt(3)
    buffer_load_dwordx4 v[140:143], v2, s[44:47], s10 offen offset:256 nt
    s_andn2_b32 s80, s7, 7
    s_cmp_ge_u32 s3, 3
    s_cselect_b32 s81, 5, 0
    s_add_u32 s81, s81, s3
    s_cmp_lt_u32 s3, 3
    s_cselect_b32 s81, s81, 0
    s_add_u32 s80, s80, s81
    s_lshl_b32 s80, s80, 9
    s_add_u32 s80, s80, 65536
    s_cmp_lt_u32 s74, 24
    s_cselect_b32 s81, s3, 99
    s_movk_i32 s83, 1536
    s_cmp_eq_u32 s81, 3
    s_cselect_b32 s80, s27, s80
    s_cselect_b32 s83, 512, s83
    v_lshrrev_b32 v9, 5, v1
    v_mul_u32_u24 v9, s83, v9
    v_and_b32 v10, 31, v1
    v_lshl_add_u32 v9, v10, 4, v9
    v_add_u32 v46, s80, v9
    buffer_load_dwordx4 v[40:43], v46, s[76:79], 0 offen sc1
    s_add_u32 s10, s9, 983040
    s_cmp_ge_u32 s10, s8
    s_cselect_b32 s83, 3145728, 0
    s_sub_u32 s10, s10, s83
    s_waitcnt vmcnt(4)
    buffer_load_dwordx4 v[144:147], v2, s[44:47], s10 offen offset:0 nt
    s_waitcnt vmcnt(4)
    buffer_load_dwordx4 v[148:151], v2, s[44:47], s10 offen offset:128 nt
    s_waitcnt vmcnt(4)
    buffer_load_dwordx4 v[152:155], v2, s[44:47], s10 offen offset:256 nt
    s_add_u32 s10, s9, 1179648
    s_cmp_ge_u32 s10, s8
    s_cselect_b32 s83, 3145728, 0
    s_sub_u32 s10, s10, s83
    s_waitcnt vmcnt(4)
    buffer_load_dwordx4 v[156:159], v2, s[44:47], s10 offen offset:0 nt
    s_waitcnt vmcnt(3)
    buffer_load_dwordx4 v[160:163], v2, s[44:47], s10 offen offset:128 nt
    v_perm_b32 v9, v41, v40, s72
    v_perm_b32 v10, v43, v42, s72
    v_lshl_or_b32 v9, v10, 16, v9
    v_cmp_ne_u32 vcc, s75, v9
    s_nop 0
    s_cmp_lg_u64 vcc, 0
    s_cbranch_scc1 Lq_slow
Lq_ok:
    s_nop 0
    v_and_b32 v40, s73, v40
    v_and_b32 v41, s73, v41
    v_and_b32 v42, s73, v42
    v_and_b32 v43, s73, v43
    s_nop 0
    v_permlane32_swap_b32 v40, v42
    v_permlane32_swap_b32 v41, v43
    v_add_f32 v40, v40, v42
    v_add_f32 v41, v41, v43
    v_cvt_pk_bf16_f32 v41, v40, v41
    s_cmp_lt_u32 s3, 3
    s_cbranch_scc1 Lqh
    v_lshlrev_b32 v40, 16, v41
    v_and_b32 v41, s13, v41
    v_lshlrev_b32 v9, 16, v79
    v_and_b32 v10, s13, v79
    v_add_f32 v40, v40, v9
    v_add_f32 v41, v41, v10
    v_cvt_pk_bf16_f32 v41, v40, v41
    v_lshlrev_b32 v40, 16, v41
    v_and_b32 v41, s13, v41
    v_max_f32 v40, 0, v40
    v_max_f32 v41, 0, v41
    v_mul_f32 v40, v40, v40
    v_mul_f32 v41, v41, v41
    v_cvt_pk_bf16_f32 v41, v40, v41
Lqh:
    s_mul_i32 s80, s3, 43
    s_lshr_b32 s80, s80, 7
    s_mul_i32 s80, s80, 3
    s_add_u32 s80, s80, s3
    s_lshl_b32 s80, s80, 7
    v_bfe_u32 v9, v1, 4, 1
    v_mul_u32_u24 v9, 384, v9
    v_add3_u32 v10, s80, v9, v47
    v_and_b32 v6, 7, v1
    v_lshlrev_b32 v6, 4, v6
    s_cmp_gt_u32 s3, 3
    s_cbranch_scc1 Lqw
    ds_write_b32 v10, v41 offset:6656
Lqw:
    s_waitcnt lgkmcnt(0)
    s_barrier
    ds_read_b128 v[40:43], v6 offset:6656
    ds_read_b128 v[44:47], v6 offset:6784
    ds_read_b128 v[48:51], v6 offset:6912
    s_waitcnt lgkmcnt(0)
    v_mov_b32 v52, 0
    v_dot2c_f32_bf16 v52, v84, v40
    v_dot2c_f32_bf16 v52, v85, v41
    v_dot2c_f32_bf16 v52, v86, v42
    v_dot2c_f32_bf16 v52, v87, v43
    v_dot2c_f32_bf16 v52, v88, v44
    v_dot2c_f32_bf16 v52, v89, v45
    v_dot2c_f32_bf16 v52, v90, v46
    v_dot2c_f32_bf16 v52, v91, v47
    v_dot2c_f32_bf16 v52, v92, v48
    v_dot2c_f32_bf16 v52, v93, v49
    v_dot2c_f32_bf16 v52, v94, v50
    v_dot2c_f32_bf16 v52, v95, v51
    v_mov_b32 v53, 0
    v_dot2c_f32_bf16 v53, v96, v40
    v_dot2c_f32_bf16 v53, v97, v41
    v_dot2c_f32_bf16 v53, v98, v42
    v_dot2c_f32_bf16 v53, v99, v43
    v_dot2c_f32_bf16 v53, v100, v44
    v_dot2c_f32_bf16 v53, v101, v45
    v_dot2c_f32_bf16 v53, v102, v46
    v_dot2c_f32_bf16 v53, v103, v47
    v_dot2c_f32_bf16 v53, v104, v48
    v_dot2c_f32_bf16 v53, v105, v49
    v_dot2c_f32_bf16 v53, v106, v50
    v_dot2c_f32_bf16 v53, v107, v51
    s_waitcnt vmcnt(3)
    s_cmp_lt_u32 s38, 1
    s_cbranch_scc1 Lfb1
    s_waitcnt vmcnt(2)
    s_cmp_lt_u32 s38, 2
    s_cbranch_scc1 Lfb1
    s_waitcnt vmcnt(1)
Lfb1:
    buffer_load_dwordx4 v[164:167], v2, s[44:47], s10 offen offset:256 nt
    v_mov_b32 v54, 0
    v_dot2c_f32_bf16 v54, v108, v40
    v_dot2c_f32_bf16 v54, v109, v41
    v_add_f32_dpp v52, v52, v52 quad_perm:[1,0,3,2] row_mask:0xf bank_mask:0xf
    v_dot2c_f32_bf16 v54, v110, v42
    v_add_f32_dpp v53, v53, v53 quad_perm:[1,0,3,2] row_mask:0xf bank_mask:0xf
    v_dot2c_f32_bf16 v54, v111, v43
    v_add_f32_dpp v52, v52, v52 quad_perm:[2,3,0,1] row_mask:0xf bank_mask:0xf
    v_dot2c_f32_bf16 v54, v112, v44
    v_add_f32_dpp v53, v53, v53 quad_perm:[2,3,0,1] row_mask:0xf bank_mask:0xf
    v_dot2c_f32_bf16 v54, v113, v45
    v_add_f32_dpp v52, v52, v52 row_half_mirror row_mask:0xf bank_mask:0xf
    v_dot2c_f32_bf16 v54, v114, v46
    v_add_f32_dpp v53, v53, v53 row_half_mirror row_mask:0xf bank_mask:0xf
    v_dot2c_f32_bf16 v54, v115, v47
    v_cvt_pk_bf16_f32 v53, v52, v53
    v_dot2c_f32_bf16 v54, v116, v48
    v_lshlrev_b32 v52, 16, v53
    v_dot2c_f32_bf16 v54, v117, v49
    v_and_b32 v53, s13, v53
    v_dot2c_f32_bf16 v54, v118, v50
    v_mul_f32 v52, s14, v52
    v_dot2c_f32_bf16 v54, v119, v51
    v_mul_f32 v53, s14, v53
    v_mov_b32 v55, 0
    v_dot2c_f32_bf16 v55, v120, v40
    v_dot2c_f32_bf16 v55, v121, v41
    v_cvt_pk_bf16_f32 v53, v52, v53
    v_dot2c_f32_bf16 v55, v122, v42
    v_lshlrev_b32 v52, 16, v53
    v_dot2c_f32_bf16 v55, v123, v43
    v_and_b32 v53, s13, v53
    v_dot2c_f32_bf16 v55, v124, v44
    v_max3_f32 v7, v7, v52, v53
    v_dot2c_f32_bf16 v55, v125, v45
    v_dot2c_f32_bf16 v55, v126, v46
    v_dot2c_f32_bf16 v55, v127, v47
    v_dot2c_f32_bf16 v55, v128, v48
    v_dot2c_f32_bf16 v55, v129, v49
    v_dot2c_f32_bf16 v55, v130, v50
    v_dot2c_f32_bf16 v55, v131, v51
    v_mov_b32 v56, 0
    v_dot2c_f32_bf16 v56, v132, v40
    v_dot2c_f32_bf16 v56, v133, v41
    v_add_f32_dpp v54, v54, v54 quad_perm:[1,0,3,2] row_mask:0xf bank_mask:0xf
    v_dot2c_f32_bf16 v56, v134, v42
    v_add_f32_dpp v55, v55, v55 quad_perm:[1,0,3,2] row_mask:0xf bank_mask:0xf
    v_dot2c_f32_bf16 v56, v135, v43
    v_add_f32_dpp v54, v54, v54 quad_perm:[2,3,0,1] row_mask:0xf bank_mask:0xf
    v_dot2c_f32_bf16 v56, v136, v44
    v_add_f32_dpp v55, v55, v55 quad_perm:[2,3,0,1] row_mask:0xf bank_mask:0xf
    v_dot2c_f32_bf16 v56, v137, v45
    v_add_f32_dpp v54, v54, v54 row_half_mirror row_mask:0xf bank_mask:0xf
    v_dot2c_f32_bf16 v56, v138, v46
    v_add_f32_dpp v55, v55, v55 row_half_mirror row_mask:0xf bank_mask:0xf
    v_dot2c_f32_bf16 v56, v139, v47
    v_cvt_pk_bf16_f32 v55, v54, v55
    v_dot2c_f32_bf16 v56, v140, v48
    v_lshlrev_b32 v54, 16, v55
    v_dot2c_f32_bf16 v56, v141, v49
    v_and_b32 v55, s13, v55
    v_dot2c_f32_bf16 v56, v142, v50
    v_mul_f32 v54, s14, v54
    v_dot2c_f32_bf16 v56, v143, v51
    v_mul_f32 v55, s14, v55
    v_mov_b32 v57, 0
    v_dot2c_f32_bf16 v57, v144, v40
    v_dot2c_f32_bf16 v57, v145, v41
    v_cvt_pk_bf16_f32 v55, v54, v55
    v_dot2c_f32_bf16 v57, v146, v42
    v_lshlrev_b32 v54, 16, v55
    v_dot2c_f32_bf16 v57, v147, v43
    v_and_b32 v55, s13, v55
    v_dot2c_f32_bf16 v57, v148, v44
    v_max3_f32 v7, v7, v54, v55
    v_dot2c_f32_bf16 v57, v149, v45
    v_dot2c_f32_bf16 v57, v150, v46
    v_dot2c_f32_bf16 v57, v151, v47
    s_xor_b32 s80, s75, 7
    v_mov_b32 v9, s80
    s_mov_b64 exec, 1
    buffer_store_dword v9, v5, s[76:79], s39 offen
    s_mov_b64 exec, -1
    s_nop 0
    s_add_u32 s10, s9, 1376256
    s_cmp_ge_u32 s10, s8
    s_cselect_b32 s83, 3145728, 0
    s_sub_u32 s10, s10, s83
    s_waitcnt vmcnt(4)
    s_cmp_lt_u32 s38, 1
    s_cbranch_scc1 Lfb2
    s_waitcnt vmcnt(3)
    s_cmp_lt_u32 s38, 2
    s_cbranch_scc1 Lfb2
    s_waitcnt vmcnt(2)
Lfb2:
    buffer_load_dwordx4 v[84:87], v2, s[44:47], s10 offen offset:0 nt
    v_dot2c_f32_bf16 v57, v152, v48
    v_dot2c_f32_bf16 v57, v153, v49
    v_dot2c_f32_bf16 v57, v154, v50
    v_dot2c_f32_bf16 v57, v155, v51
    s_waitcnt vmcnt(4)
    s_cmp_lt_u32 s38, 1
    s_cbranch_scc1 Lfb3
    s_waitcnt vmcnt(3)
    s_cmp_lt_u32 s38, 2
    s_cbranch_scc1 Lfb3
    s_waitcnt vmcnt(2)
Lfb3:
    buffer_load_dwordx4 v[88:91], v2, s[44:47], s10 offen offset:128 nt
    v_mov_b32 v58, 0
    v_dot2c_f32_bf16 v58, v156, v40
    v_dot2c_f32_bf16 v58, v157, v41
    v_add_f32_dpp v56, v56, v56 quad_perm:[1,0,3,2] row_mask:0xf bank_mask:0xf
    v_dot2c_f32_bf16 v58, v158, v42
    v_add_f32_dpp v57, v57, v57 quad_perm:[1,0,3,2] row_mask:0xf bank_mask:0xf
    v_dot2c_f32_bf16 v58, v159, v43
    v_add_f32_dpp v56, v56, v56 quad_perm:[2,3,0,1] row_mask:0xf bank_mask:0xf
    s_waitcnt vmcnt(4)
    s_cmp_lt_u32 s38, 1
    s_cbranch_scc1 Lfb4
    s_waitcnt vmcnt(3)
    s_cmp_lt_u32 s38, 2
    s_cbranch_scc1 Lfb4
    s_waitcnt vmcnt(1)
Lfb4:
    buffer_load_dwordx4 v[92:95], v2, s[44:47], s10 offen offset:256 nt
    v_dot2c_f32_bf16 v58, v160, v44
    v_add_f32_dpp v57, v57, v57 quad_perm:[2,3,0,1] row_mask:0xf bank_mask:0xf
    v_dot2c_f32_bf16 v58, v161, v45
    v_add_f32_dpp v56, v56, v56 row_half_mirror row_mask:0xf bank_mask:0xf
    v_dot2c_f32_bf16 v58, v162, v46
    v_add_f32_dpp v57, v57, v57 row_half_mirror row_mask:0xf bank_mask:0xf
    v_dot2c_f32_bf16 v58, v163, v47
    v_cvt_pk_bf16_f32 v57, v56, v57
    s_barrier
    s_xor_b32 s80, s75, 8
    v_mov_b32 v9, s80
    s_mov_b64 exec, 1
    buffer_store_dword v9, v5, s[76:79], s39 offen
    s_lshr_b32 s80, s7, 5
    s_lshl_b32 s80, s80, 8
    s_add_u32 s80, s80, 40960
    s_mov_b32 exec_lo, -1
    buffer_load_dword v254, v5, s[76:79], s80 offen sc1
    s_mov_b64 exec, -1
    s_nop 0
    s_add_u32 s10, s9, 1572864
    s_cmp_ge_u32 s10, s8
    s_cselect_b32 s83, 3145728, 0
    s_sub_u32 s10, s10, s83
    s_waitcnt vmcnt(6)
    s_cmp_lt_u32 s38, 1
    s_cbranch_scc1 Lfb5
    s_waitcnt vmcnt(4)
    s_cmp_lt_u32 s38, 2
    s_cbranch_scc1 Lfb5
    s_waitcnt vmcnt(3)
Lfb5:
    buffer_load_dwordx4 v[96:99], v2, s[44:47], s10 offen offset:0 nt
    v_dot2c_f32_bf16 v58, v164, v48
    v_lshlrev_b32 v56, 16, v57
    v_dot2c_f32_bf16 v58, v165, v49
    v_and_b32 v57, s13, v57
    v_dot2c_f32_bf16 v58, v166, v50
    v_mul_f32 v56, s14, v56
    v_dot2c_f32_bf16 v58, v167, v51
    v_mul_f32 v57, s14, v57
    s_waitcnt vmcnt(5)
    s_cmp_lt_u32 s38, 1
    s_cbranch_scc1 Lfb6
    s_waitcnt vmcnt(4)
    s_cmp_lt_u32 s38, 2
    s_cbranch_scc1 Lfb6
    s_waitcnt vmcnt(3)
Lfb6:
    buffer_load_dwordx4 v[100:103], v2, s[44:47], s10 offen offset:128 nt
    v_mov_b32 v59, 0
    v_dot2c_f32_bf16 v59, v84, v40
    v_dot2c_f32_bf16 v59, v85, v41
    v_cvt_pk_bf16_f32 v57, v56, v57
    v_dot2c_f32_bf16 v59, v86, v42
    v_lshlrev_b32 v56, 16, v57
    v_dot2c_f32_bf16 v59, v87, v43
    v_and_b32 v57, s13, v57
    s_waitcnt vmcnt(5)
    s_cmp_lt_u32 s38, 1
    s_cbranch_scc1 Lfb7
    s_waitcnt vmcnt(4)
    s_cmp_lt_u32 s38, 2
    s_cbranch_scc1 Lfb7
    s_waitcnt vmcnt(1)
Lfb7:
    buffer_load_dwordx4 v[104:107], v2, s[44:47], s10 offen offset:256 nt
    v_dot2c_f32_bf16 v59, v88, v44
    v_max3_f32 v7, v7, v56, v57
    v_dot2c_f32_bf16 v59, v89, v45
    v_dot2c_f32_bf16 v59, v90, v46
    v_dot2c_f32_bf16 v59, v91, v47
    s_xor_b32 s80, s75, 9
    v_mov_b32 v9, s80
    s_mov_b64 exec, 1
    buffer_store_dword v9, v5, s[76:79], s39 offen
    s_mov_b64 exec, -1
    s_nop 0
    s_add_u32 s10, s9, 1769472
    s_cmp_ge_u32 s10, s8
    s_cselect_b32 s83, 3145728, 0
    s_sub_u32 s10, s10, s83
    s_waitcnt vmcnt(6)
    s_cmp_lt_u32 s38, 1
    s_cbranch_scc1 Lfb8
    s_waitcnt vmcnt(3)
    s_cmp_lt_u32 s38, 2
    s_cbranch_scc1 Lfb8
    s_waitcnt vmcnt(2)
Lfb8:
    buffer_load_dwordx4 v[108:111], v2, s[44:47], s10 offen offset:0 nt
    v_dot2c_f32_bf16 v59, v92, v48
    v_dot2c_f32_bf16 v59, v93, v49
    v_dot2c_f32_bf16 v59, v94, v50
    v_dot2c_f32_bf16 v59, v95, v51
    s_waitcnt vmcnt(4)
    s_cmp_lt_u32 s38, 1
    s_cbranch_scc1 Lfb9
    s_waitcnt vmcnt(3)
    s_cmp_lt_u32 s38, 2
    s_cbranch_scc1 Lfb9
    s_waitcnt vmcnt(2)
Lfb9:
    buffer_load_dwordx4 v[112:115], v2, s[44:47], s10 offen offset:128 nt
    v_xor_b32 v9, s75, v254
    v_min_u32 v9, 64, v9
    s_and_b32 s80, s7, 31
    s_nop 1
    v_readlane_b32 s81, v9, s80
    s_nop 1
    v_cmp_gt_u32 vcc, s81, v9
    s_nop 1
    s_bcnt1_i32_b32 s82, vcc_lo
    v_cmp_lt_u32 vcc, s81, v9
    s_nop 1
    s_bcnt1_i32_b32 s83, vcc_lo
    s_sub_i32 s82, s82, s83
    v_cmp_eq_u32 vcc, 64, v9
    s_nop 1
    s_bcnt1_i32_b32 s83, vcc_lo
    s_add_i32 s82, s82, s83
    s_cmp_gt_i32 s82, 99
    s_cselect_b32 s38, 2, 1
    s_cmp_lt_i32 s82, -4
    s_cselect_b32 s38, 0, s38
    v_mov_b32 v60, 0
    v_dot2c_f32_bf16 v60, v96, v40
    v_dot2c_f32_bf16 v60, v97, v41
    v_add_f32_dpp v58, v58, v58 quad_perm:[1,0,3,2] row_mask:0xf bank_mask:0xf
    v_dot2c_f32_bf16 v60, v98, v42
    v_add_f32_dpp v59, v59, v59 quad_perm:[1,0,3,2] row_mask:0xf bank_mask:0xf
    v_dot2c_f32_bf16 v60, v99, v43
    v_add_f32_dpp v58, v58, v58 quad_perm:[2,3,0,1] row_mask:0xf bank_mask:0xf
    s_waitcnt vmcnt(4)
    s_cmp_lt_u32 s38, 1
    s_cbranch_scc1 Lfb10
    s_waitcnt vmcnt(3)
    s_cmp_lt_u32 s38, 2
    s_cbranch_scc1 Lfb10
    s_waitcnt vmcnt(1)
Lfb10:
    buffer_load_dwordx4 v[116:119], v2, s[44:47], s10 offen offset:256 nt
    v_dot2c_f32_bf16 v60, v100, v44
    v_add_f32_dpp v59, v59, v59 quad_perm:[2,3,0,1] row_mask:0xf bank_mask:0xf
    v_dot2c_f32_bf16 v60, v101, v45
    v_add_f32_dpp v58, v58, v58 row_half_mirror row_mask:0xf bank_mask:0xf
    v_dot2c_f32_bf16 v60, v102, v46
    v_add_f32_dpp v59, v59, v59 row_half_mirror row_mask:0xf bank_mask:0xf
    v_dot2c_f32_bf16 v60, v103, v47
    v_cvt_pk_bf16_f32 v59, v58, v59
    s_barrier
    s_xor_b32 s80, s75, 10
    v_mov_b32 v9, s80
    s_mov_b64 exec, 1
    buffer_store_dword v9, v5, s[76:79], s39 offen
    s_lshr_b32 s80, s7, 5
    s_lshl_b32 s80, s80, 8
    s_add_u32 s80, s80, 40960
    s_mov_b32 exec_lo, -1
    buffer_load_dword v254, v5, s[76:79], s80 offen sc1
    s_mov_b64 exec, -1
    s_nop 0
    s_add_u32 s10, s9, 1966080
    s_cmp_ge_u32 s10, s8
    s_cselect_b32 s83, 3145728, 0
    s_sub_u32 s10, s10, s83
    s_waitcnt vmcnt(6)
    s_cmp_lt_u32 s38, 1
    s_cbranch_scc1 Lfb11
    s_waitcnt vmcnt(4)
    s_cmp_lt_u32 s38, 2
    s_cbranch_scc1 Lfb11
    s_waitcnt vmcnt(3)
Lfb11:
    buffer_load_dwordx4 v[84:87], v2, s[44:47], s10 offen offset:0 nt
    v_dot2c_f32_bf16 v60, v104, v48
    v_lshlrev_b32 v58, 16, v59
    v_dot2c_f32_bf16 v60, v105, v49
    v_and_b32 v59, s13, v59
    v_dot2c_f32_bf16 v60, v106, v50
    v_mul_f32 v58, s14, v58
    v_dot2c_f32_bf16 v60, v107, v51
    v_mul_f32 v59, s14, v59
    s_waitcnt vmcnt(5)
    s_cmp_lt_u32 s38, 1
    s_cbranch_scc1 Lfb12
    s_waitcnt vmcnt(4)
    s_cmp_lt_u32 s38, 2
    s_cbranch_scc1 Lfb12
    s_waitcnt vmcnt(3)
Lfb12:
    buffer_load_dwordx4 v[88:91], v2, s[44:47], s10 offen offset:128 nt
    v_mov_b32 v61, 0
    v_dot2c_f32_bf16 v61, v108, v40
    v_dot2c_f32_bf16 v61, v109, v41
    v_cvt_pk_bf16_f32 v59, v58, v59
    v_dot2c_f32_bf16 v61, v110, v42
    v_lshlrev_b32 v58, 16, v59
    v_dot2c_f32_bf16 v61, v111, v43
    v_and_b32 v59, s13, v59
    s_waitcnt vmcnt(5)
    s_cmp_lt_u32 s38, 1
    s_cbranch_scc1 Lfb13
    s_waitcnt vmcnt(4)
    s_cmp_lt_u32 s38, 2
    s_cbranch_scc1 Lfb13
    s_waitcnt vmcnt(1)
Lfb13:
    buffer_load_dwordx4 v[92:95], v2, s[44:47], s10 offen offset:256 nt
    v_dot2c_f32_bf16 v61, v112, v44
    v_max3_f32 v7, v7, v58, v59
    v_dot2c_f32_bf16 v61, v113, v45
    v_dot2c_f32_bf16 v61, v114, v46
    v_dot2c_f32_bf16 v61, v115, v47
    s_xor_b32 s80, s75, 11
    v_mov_b32 v9, s80
    s_mov_b64 exec, 1
    buffer_store_dword v9, v5, s[76:79], s39 offen
    s_mov_b64 exec, -1
    s_nop 0
    s_add_u32 s10, s9, 2162688
    s_cmp_ge_u32 s10, s8
    s_cselect_b32 s83, 3145728, 0
    s_sub_u32 s10, s10, s83
    s_waitcnt vmcnt(6)
    s_cmp_lt_u32 s38, 1
    s_cbranch_scc1 Lfb14
    s_waitcnt vmcnt(3)
    s_cmp_lt_u32 s38, 2
    s_cbranch_scc1 Lfb14
    s_waitcnt vmcnt(2)
Lfb14:
    buffer_load_dwordx4 v[96:99], v2, s[44:47], s10 offen offset:0 nt
    v_dot2c_f32_bf16 v61, v116, v48
    v_dot2c_f32_bf16 v61, v117, v49
    v_dot2c_f32_bf16 v61, v118, v50
    v_dot2c_f32_bf16 v61, v119, v51
    s_waitcnt vmcnt(4)
    s_cmp_lt_u32 s38, 1
    s_cbranch_scc1 Lfb15
    s_waitcnt vmcnt(3)
    s_cmp_lt_u32 s38, 2
    s_cbranch_scc1 Lfb15
    s_waitcnt vmcnt(2)
Lfb15:
    buffer_load_dwordx4 v[100:103], v2, s[44:47], s10 offen offset:128 nt
    v_xor_b32 v9, s75, v254
    v_min_u32 v9, 64, v9
    s_and_b32 s80, s7, 31
    s_nop 1
    v_readlane_b32 s81, v9, s80
    s_nop 1
    v_cmp_gt_u32 vcc, s81, v9
    s_nop 1
    s_bcnt1_i32_b32 s82, vcc_lo
    v_cmp_lt_u32 vcc, s81, v9
    s_nop 1
    s_bcnt1_i32_b32 s83, vcc_lo
    s_sub_i32 s82, s82, s83
    v_cmp_eq_u32 vcc, 64, v9
    s_nop 1
    s_bcnt1_i32_b32 s83, vcc_lo
    s_add_i32 s82, s82, s83
    s_cmp_gt_i32 s82, 99
    s_cselect_b32 s38, 2, 1
    s_cmp_lt_i32 s82, -4
    s_cselect_b32 s38, 0, s38
    v_mov_b32 v62, 0
    v_dot2c_f32_bf16 v62, v84, v40
    v_dot2c_f32_bf16 v62, v85, v41
    v_add_f32_dpp v60, v60, v60 quad_perm:[1,0,3,2] row_mask:0xf bank_mask:0xf
    v_dot2c_f32_bf16 v62, v86, v42
    v_add_f32_dpp v61, v61, v61 quad_perm:[1,0,3,2] row_mask:0xf bank_mask:0xf
    v_dot2c_f32_bf16 v62, v87, v43
    v_add_f32_dpp v60, v60, v60 quad_perm:[2,3,0,1] row_mask:0xf bank_mask:0xf
    s_waitcnt vmcnt(4)
    s_cmp_lt_u32 s38, 1
    s_cbranch_scc1 Lfb16
    s_waitcnt vmcnt(3)
    s_cmp_lt_u32 s38, 2
    s_cbranch_scc1 Lfb16
    s_waitcnt vmcnt(1)
Lfb16:
    buffer_load_dwordx4 v[104:107], v2, s[44:47], s10 offen offset:256 nt
    v_dot2c_f32_bf16 v62, v88, v44
    v_add_f32_dpp v61, v61, v61 quad_perm:[2,3,0,1] row_mask:0xf bank_mask:0xf
    v_dot2c_f32_bf16 v62, v89, v45
    v_add_f32_dpp v60, v60, v60 row_half_mirror row_mask:0xf bank_mask:0xf
    v_dot2c_f32_bf16 v62, v90, v46
    v_add_f32_dpp v61, v61, v61 row_half_mirror row_mask:0xf bank_mask:0xf
    v_dot2c_f32_bf16 v62, v91, v47
    v_cvt_pk_bf16_f32 v61, v60, v61
    s_barrier
    s_xor_b32 s80, s75, 12
    v_mov_b32 v9, s80
    s_mov_b64 exec, 1
    buffer_store_dword v9, v5, s[76:79], s39 offen
    s_lshr_b32 s80, s7, 5
    s_lshl_b32 s80, s80, 8
    s_add_u32 s80, s80, 40960
    s_mov_b32 exec_lo, -1
    buffer_load_dword v254, v5, s[76:79], s80 offen sc1
    s_mov_b64 exec, -1
    s_nop 0
    s_add_u32 s10, s9, 2359296
    s_cmp_ge_u32 s10, s8
    s_cselect_b32 s83, 3145728, 0
    s_sub_u32 s10, s10, s83
    s_waitcnt vmcnt(6)
    s_cmp_lt_u32 s38, 1
    s_cbranch_scc1 Lfb17
    s_waitcnt vmcnt(4)
    s_cmp_lt_u32 s38, 2
    s_cbranch_scc1 Lfb17
    s_waitcnt vmcnt(3)
Lfb17:
    buffer_load_dwordx4 v[108:111], v2, s[44:47], s10 offen offset:0 nt
    v_dot2c_f32_bf16 v62, v92, v48
    v_lshlrev_b32 v60, 16, v61
    v_dot2c_f32_bf16 v62, v93, v49
    v_and_b32 v61, s13, v61
    v_dot2c_f32_bf16 v62, v94, v50
    v_mul_f32 v60, s14, v60
    v_dot2c_f32_bf16 v62, v95, v51
    v_mul_f32 v61, s14, v61
    s_waitcnt vmcnt(5)
    s_cmp_lt_u32 s38, 1
    s_cbranch_scc1 Lfb18
    s_waitcnt vmcnt(4)
    s_cmp_lt_u32 s38, 2
    s_cbranch_scc1 Lfb18
    s_waitcnt vmcnt(3)
Lfb18:
    buffer_load_dwordx4 v[112:115], v2, s[44:47], s10 offen offset:128 nt
    v_mov_b32 v63, 0
    v_dot2c_f32_bf16 v63, v96, v40
    v_dot2c_f32_bf16 v63, v97, v41
    v_cvt_pk_bf16_f32 v61, v60, v61
    v_dot2c_f32_bf16 v63, v98, v42
    v_lshlrev_b32 v60, 16, v61
    v_dot2c_f32_bf16 v63, v99, v43
    v_and_b32 v61, s13, v61
    s_waitcnt vmcnt(5)
    s_cmp_lt_u32 s38, 1
    s_cbranch_scc1 Lfb19
    s_waitcnt vmcnt(4)
    s_cmp_lt_u32 s38, 2
    s_cbranch_scc1 Lfb19
    s_waitcnt vmcnt(1)
Lfb19:
    buffer_load_dwordx4 v[116:119], v2, s[44:47], s10 offen offset:256 nt
    v_dot2c_f32_bf16 v63, v100, v44
    v_max3_f32 v7, v7, v60, v61
    v_dot2c_f32_bf16 v63, v101, v45
    v_dot2c_f32_bf16 v63, v102, v46
    v_dot2c_f32_bf16 v63, v103, v47
    s_xor_b32 s80, s75, 13
    v_mov_b32 v9, s80
    s_mov_b64 exec, 1
    buffer_store_dword v9, v5, s[76:79], s39 offen
    s_mov_b64 exec, -1
    s_nop 0
    s_add_u32 s10, s9, 2555904
    s_cmp_ge_u32 s10, s8
    s_cselect_b32 s83, 3145728, 0
    s_sub_u32 s10, s10, s83
    s_waitcnt vmcnt(6)
    s_cmp_lt_u32 s38, 1
    s_cbranch_scc1 Lfb20
    s_waitcnt vmcnt(3)
    s_cmp_lt_u32 s38, 2
    s_cbranch_scc1 Lfb20
    s_waitcnt vmcnt(2)
Lfb20:
    buffer_load_dwordx4 v[84:87], v2, s[44:47], s10 offen offset:0 nt
    v_dot2c_f32_bf16 v63, v104, v48
    v_dot2c_f32_bf16 v63, v105, v49
    v_dot2c_f32_bf16 v63, v106, v50
    v_dot2c_f32_bf16 v63, v107, v51
    v_lshrrev_b32 v9, 3, v1
    s_lshl_b32 s80, s3, 4
    v_lshl_add_u32 v9, v9, 1, s80
    ds_read_u16 v12, v9 offset:7424
    ds_read_u16 v13, v9 offset:7808
    v_mov_b32 v16, 0
    v_mov_b32 v17, 0
    v_mov_b32 v18, 0
    v_mov_b32 v19, 0
    v_mov_b32 v20, 0
    v_mov_b32 v21, 0
    v_mov_b32 v22, 0
    v_mov_b32 v23, 0
    v_mov_b32 v24, 0
    v_mov_b32 v25, 0
    v_mov_b32 v26, 0
    v_mov_b32 v27, 0
    v_mov_b32 v28, 0
    v_mov_b32 v29, 0
    v_mov_b32 v30, 0
    v_mov_b32 v31, 0
    s_waitcnt lgkmcnt(0)
    v_lshlrev_b32 v9, 16, v12
    v_lshlrev_b32 v10, 16, v13
    v_dot2c_f32_bf16 v16, v80, v12
    v_dot2c_f32_bf16 v17, v80, v9
    v_dot2c_f32_bf16 v18, v81, v12
    v_dot2c_f32_bf16 v19, v81, v9
    v_dot2c_f32_bf16 v20, v82, v12
    v_dot2c_f32_bf16 v21, v82, v9
    v_dot2c_f32_bf16 v22, v83, v12
    v_dot2c_f32_bf16 v23, v83, v9
    v_dot2c_f32_bf16 v24, v80, v13
    v_dot2c_f32_bf16 v25, v80, v10
    v_dot2c_f32_bf16 v26, v81, v13
    v_dot2c_f32_bf16 v27, v81, v10
    v_dot2c_f32_bf16 v28, v82, v13
    v_dot2c_f32_bf16 v29, v82, v10
    v_dot2c_f32_bf16 v30, v83, v13
    v_dot2c_f32_bf16 v31, v83, v10
    v_and_b32 v11, 7, v1
    v_lshlrev_b32 v11, 5, v11
    s_lshl_b32 s80, s3, 9
    v_add_u32 v11, s80, v11
    v_bfe_u32 v9, v1, 5, 1
    v_lshl_add_u32 v11, v9, 8, v11
    v_bfe_u32 v9, v1, 3, 2
    v_lshl_add_u32 v11, v9, 3, v11
    v_permlane32_swap_b32 v16, v24
    v_permlane32_swap_b32 v17, v25
    v_permlane32_swap_b32 v18, v26
    v_permlane32_swap_b32 v19, v27
    v_permlane32_swap_b32 v20, v28
    v_permlane32_swap_b32 v21, v29
    v_permlane32_swap_b32 v22, v30
    v_permlane32_swap_b32 v23, v31
    v_add_f32 v16, v16, v24
    v_add_f32 v17, v17, v25
    v_add_f32 v18, v18, v26
    v_add_f32 v19, v19, v27
    v_add_f32 v20, v20, v28
    v_add_f32 v21, v21, v29
    v_add_f32 v22, v22, v30
    v_add_f32 v23, v23, v31
    v_permlane16_swap_b32 v16, v20
    v_permlane16_swap_b32 v17, v21
    v_permlane16_swap_b32 v18, v22
    v_permlane16_swap_b32 v19, v23
    v_add_f32 v16, v16, v20
    v_add_f32 v17, v17, v21
    v_add_f32 v18, v18, v22
    v_add_f32 v19, v19, v23
    v_add_f32_dpp v20, v16, v16 row_ror:8 row_mask:0xf bank_mask:0x3
    v_add_f32_dpp v21, v17, v17 row_ror:8 row_mask:0xf bank_mask:0x3
    s_nop 0
    v_add_f32_dpp v20, v18, v18 row_ror:8 row_mask:0xf bank_mask:0xc
    v_add_f32_dpp v21, v19, v19 row_ror:8 row_mask:0xf bank_mask:0xc
    ds_write_b64 v11, v[20:21] offset:9216
    s_waitcnt lgkmcnt(0)
    s_waitcnt vmcnt(4)
    s_cmp_lt_u32 s38, 1
    s_cbranch_scc1 Lfb21
    s_waitcnt vmcnt(3)
    s_cmp_lt_u32 s38, 2
    s_cbranch_scc1 Lfb21
    s_waitcnt vmcnt(2)
Lfb21:
    buffer_load_dwordx4 v[88:91], v2, s[44:47], s10 offen offset:128 nt
    v_xor_b32 v9, s75, v254
    v_min_u32 v9, 64, v9
    s_and_b32 s80, s7, 31
    s_nop 1
    v_readlane_b32 s81, v9, s80
    s_nop 1
    v_cmp_gt_u32 vcc, s81, v9
    s_nop 1
    s_bcnt1_i32_b32 s82, vcc_lo
    v_cmp_lt_u32 vcc, s81, v9
    s_nop 1
    s_bcnt1_i32_b32 s83, vcc_lo
    s_sub_i32 s82, s82, s83
    v_cmp_eq_u32 vcc, 64, v9
    s_nop 1
    s_bcnt1_i32_b32 s83, vcc_lo
    s_add_i32 s82, s82, s83
    s_cmp_gt_i32 s82, 99
    s_cselect_b32 s38, 2, 1
    s_cmp_lt_i32 s82, -4
    s_cselect_b32 s38, 0, s38
    v_mov_b32 v64, 0
    v_dot2c_f32_bf16 v64, v108, v40
    v_dot2c_f32_bf16 v64, v109, v41
    v_add_f32_dpp v62, v62, v62 quad_perm:[1,0,3,2] row_mask:0xf bank_mask:0xf
    v_dot2c_f32_bf16 v64, v110, v42
    v_add_f32_dpp v63, v63, v63 quad_perm:[1,0,3,2] row_mask:0xf bank_mask:0xf
    v_dot2c_f32_bf16 v64, v111, v43
    v_add_f32_dpp v62, v62, v62 quad_perm:[2,3,0,1] row_mask:0xf bank_mask:0xf
    s_waitcnt vmcnt(4)
    s_cmp_lt_u32 s38, 1
    s_cbranch_scc1 Lfb22
    s_waitcnt vmcnt(3)
    s_cmp_lt_u32 s38, 2
    s_cbranch_scc1 Lfb22
    s_waitcnt vmcnt(1)
Lfb22:
    buffer_load_dwordx4 v[92:95], v2, s[44:47], s10 offen offset:256 nt
    v_dot2c_f32_bf16 v64, v112, v44
    v_add_f32_dpp v63, v63, v63 quad_perm:[2,3,0,1] row_mask:0xf bank_mask:0xf
    v_dot2c_f32_bf16 v64, v113, v45
    v_add_f32_dpp v62, v62, v62 row_half_mirror row_mask:0xf bank_mask:0xf
    v_dot2c_f32_bf16 v64, v114, v46
    v_add_f32_dpp v63, v63, v63 row_half_mirror row_mask:0xf bank_mask:0xf
    v_dot2c_f32_bf16 v64, v115, v47
    v_cvt_pk_bf16_f32 v63, v62, v63
    s_barrier
    s_xor_b32 s80, s75, 14
    v_mov_b32 v9, s80
    s_mov_b64 exec, 1
    buffer_store_dword v9, v5, s[76:79], s39 offen
    s_lshr_b32 s80, s7, 5
    s_lshl_b32 s80, s80, 8
    s_add_u32 s80, s80, 40960
    s_mov_b32 exec_lo, -1
    buffer_load_dword v254, v5, s[76:79], s80 offen sc1
    s_mov_b64 exec, -1
    s_nop 0
    s_add_u32 s10, s9, 2752512
    s_cmp_ge_u32 s10, s8
    s_cselect_b32 s83, 3145728, 0
    s_sub_u32 s10, s10, s83
    s_waitcnt vmcnt(6)
    s_cmp_lt_u32 s38, 1
    s_cbranch_scc1 Lfb23
    s_waitcnt vmcnt(4)
    s_cmp_lt_u32 s38, 2
    s_cbranch_scc1 Lfb23
    s_waitcnt vmcnt(3)
Lfb23:
    buffer_load_dwordx4 v[96:99], v2, s[44:47], s10 offen offset:0 nt
    v_dot2c_f32_bf16 v64, v116, v48
    v_lshlrev_b32 v62, 16, v63
    v_dot2c_f32_bf16 v64, v117, v49
    v_and_b32 v63, s13, v63
    v_dot2c_f32_bf16 v64, v118, v50
    v_mul_f32 v62, s14, v62
    v_dot2c_f32_bf16 v64, v119, v51
    v_mul_f32 v63, s14, v63
    s_cmp_eq_u32 s3, 0
    s_cselect_b32 s81, s26, 1073741824
    v_and_b32 v10, 31, v1
    v_lshlrev_b32 v10, 4, v10
    v_bfe_u32 v9, v1, 5, 1
    v_lshl_add_u32 v9, v9, 11, v10
    ds_read_b128 v[16:19], v9 offset:9216
    ds_read_b128 v[20:23], v9 offset:9728
    ds_read_b128 v[24:27], v9 offset:10240
    ds_read_b128 v[28:31], v9 offset:10752
    s_waitcnt lgkmcnt(0)
    v_add_f32 v16, v16, v24
    v_add_f32 v17, v17, v25
    v_add_f32 v18, v18, v26
    v_add_f32 v19, v19, v27
    v_add_f32 v20, v20, v28
    v_add_f32 v21, v21, v29
    v_add_f32 v22, v22, v30
    v_add_f32 v23, v23, v31
    v_add_f32 v16, v16, v20
    v_add_f32 v17, v17, v21
    v_add_f32 v18, v18, v22
    v_add_f32 v19, v19, v23
    v_mov_b32 v20, v16
    v_mov_b32 v21, v17
    v_mov_b32 v22, v18
    v_mov_b32 v23, v19
    v_permlane32_swap_b32 v16, v20
    v_permlane32_swap_b32 v17, v21
    v_permlane32_swap_b32 v18, v22
    v_permlane32_swap_b32 v19, v23
    v_add_f32 v16, v16, v20
    v_add_f32 v17, v17, v21
    v_add_f32 v18, v18, v22
    v_add_f32 v19, v19, v23
    v_mov_b32_sdwa v16, s75 dst_sel:BYTE_0 dst_unused:UNUSED_PRESERVE src0_sel:BYTE_0
    v_mov_b32_sdwa v17, s75 dst_sel:BYTE_0 dst_unused:UNUSED_PRESERVE src0_sel:BYTE_1
    v_mov_b32_sdwa v18, s75 dst_sel:BYTE_0 dst_unused:UNUSED_PRESERVE src0_sel:BYTE_2
    v_mov_b32_sdwa v19, s75 dst_sel:BYTE_0 dst_unused:UNUSED_PRESERVE src0_sel:BYTE_3
    s_mov_b64 exec, 0xffffffff
    buffer_store_dwordx4 v[16:19], v10, s[76:79], s81 offen sc1
    s_mov_b64 exec, -1
    s_nop 0
    v_mov_b32 v39, 0
    v_mov_b32 v38, 0
    v_mov_b32 v37, 0
    v_mov_b32 v36, 0
    v_mov_b32 v35, 0
    v_mov_b32 v34, 0
    v_mov_b32 v33, 0
    v_mov_b32 v32, 0
    v_mov_b32 v31, 0
    v_mov_b32 v30, 0
    v_mov_b32 v29, 0
    v_mov_b32 v28, 0
    v_mov_b32 v27, 0
    v_mov_b32 v26, 0
    v_mov_b32 v25, 0
    v_mov_b32 v24, 0
    v_mov_b32 v23, 0
    v_mov_b32 v22, 0
    v_mov_b32 v21, 0
    v_mov_b32 v20, 0
    v_mov_b32 v19, 0
    v_mov_b32 v18, 0
    v_mov_b32 v17, 0
    v_mov_b32 v16, 0
    v_and_b32 v15, 3, v1
    v_lshlrev_b32 v15, 7, v15
    v_bfe_u32 v9, v1, 5, 1
    v_lshl_add_u32 v15, v9, 6, v15
    v_bfe_u32 v9, v1, 4, 1
    v_lshl_add_u32 v15, v9, 5, v15
    s_lshl_b32 s80, s3, 2
    v_add_u32 v15, s80, v15
    s_waitcnt vmcnt(6)
    s_cmp_lt_u32 s38, 1
    s_cbranch_scc1 Lfb24
    s_waitcnt vmcnt(5)
    s_cmp_lt_u32 s38, 2
    s_cbranch_scc1 Lfb24
    s_waitcnt vmcnt(4)
Lfb24:
    buffer_load_dwordx4 v[100:103], v2, s[44:47], s10 offen offset:128 nt
    v_mov_b32 v65, 0
    v_dot2c_f32_bf16 v65, v84, v40
    v_dot2c_f32_bf16 v65, v85, v41
    v_cvt_pk_bf16_f32 v63, v62, v63
    v_dot2c_f32_bf16 v65, v86, v42
    v_lshlrev_b32 v62, 16, v63
    v_dot2c_f32_bf16 v65, v87, v43
    v_and_b32 v63, s13, v63
    s_waitcnt vmcnt(6)
    s_cmp_lt_u32 s38, 1
    s_cbranch_scc1 Lfb25
    s_waitcnt vmcnt(5)
    s_cmp_lt_u32 s38, 2
    s_cbranch_scc1 Lfb25
    s_waitcnt vmcnt(2)
Lfb25:
    buffer_load_dwordx4 v[104:107], v2, s[44:47], s10 offen offset:256 nt
    v_dot2c_f32_bf16 v65, v88, v44
    v_max3_f32 v7, v7, v62, v63
    v_dot2c_f32_bf16 v65, v89, v45
    v_dot2c_f32_bf16 v65, v90, v46
    v_dot2c_f32_bf16 v65, v91, v47
    s_xor_b32 s80, s75, 15
    v_mov_b32 v9, s80
    s_mov_b64 exec, 1
    buffer_store_dword v9, v5, s[76:79], s39 offen
    s_mov_b64 exec, -1
    s_nop 0
    s_add_u32 s10, s9, 2949120
    s_cmp_ge_u32 s10, s8
    s_cselect_b32 s83, 3145728, 0
    s_sub_u32 s10, s10, s83
    s_waitcnt vmcnt(7)
    s_cmp_lt_u32 s38, 1
    s_cbranch_scc1 Lfb26
    s_waitcnt vmcnt(4)
    s_cmp_lt_u32 s38, 2
    s_cbranch_scc1 Lfb26
    s_waitcnt vmcnt(2)
Lfb26:
    buffer_load_dwordx4 v[108:111], v2, s[44:47], s10 offen offset:0 nt
    v_dot2c_f32_bf16 v65, v92, v48
    v_dot2c_f32_bf16 v65, v93, v49
    v_dot2c_f32_bf16 v65, v94, v50
    v_dot2c_f32_bf16 v65, v95, v51
    s_waitcnt vmcnt(5)
    s_cmp_lt_u32 s38, 1
    s_cbranch_scc1 Lfb27
    s_waitcnt vmcnt(3)
    s_cmp_lt_u32 s38, 2
    s_cbranch_scc1 Lfb27
    s_waitcnt vmcnt(2)
Lfb27:
    buffer_load_dwordx4 v[112:115], v2, s[44:47], s10 offen offset:128 nt
    v_xor_b32 v9, s75, v254
    v_min_u32 v9, 64, v9
    s_and_b32 s80, s7, 31
    s_nop 1
    v_readlane_b32 s81, v9, s80
    s_nop 1
    v_cmp_gt_u32 vcc, s81, v9
    s_nop 1
    s_bcnt1_i32_b32 s82, vcc_lo
    v_cmp_lt_u32 vcc, s81, v9
    s_nop 1
    s_bcnt1_i32_b32 s83, vcc_lo
    s_sub_i32 s82, s82, s83
    v_cmp_eq_u32 vcc, 64, v9
    s_nop 1
    s_bcnt1_i32_b32 s83, vcc_lo
    s_add_i32 s82, s82, s83
    s_cmp_gt_i32 s82, 99
    s_cselect_b32 s38, 2, 1
    s_cmp_lt_i32 s82, -4
    s_cselect_b32 s38, 0, s38
    v_mov_b32 v66, 0
    v_dot2c_f32_bf16 v66, v96, v40
    v_dot2c_f32_bf16 v66, v97, v41
    v_add_f32_dpp v64, v64, v64 quad_perm:[1,0,3,2] row_mask:0xf bank_mask:0xf
    v_dot2c_f32_bf16 v66, v98, v42
    v_add_f32_dpp v65, v65, v65 quad_perm:[1,0,3,2] row_mask:0xf bank_mask:0xf
    v_dot2c_f32_bf16 v66, v99, v43
    v_add_f32_dpp v64, v64, v64 quad_perm:[2,3,0,1] row_mask:0xf bank_mask:0xf
    s_waitcnt vmcnt(4)
    s_cmp_lt_u32 s38, 1
    s_cbranch_scc1 Lfb28
    s_waitcnt vmcnt(3)
    s_cmp_lt_u32 s38, 2
    s_cbranch_scc1 Lfb28
    s_waitcnt vmcnt(1)
Lfb28:
    buffer_load_dwordx4 v[116:119], v2, s[44:47], s10 offen offset:256 nt
    v_dot2c_f32_bf16 v66, v100, v44
    v_add_f32_dpp v65, v65, v65 quad_perm:[2,3,0,1] row_mask:0xf bank_mask:0xf
    v_dot2c_f32_bf16 v66, v101, v45
    v_add_f32_dpp v64, v64, v64 row_half_mirror row_mask:0xf bank_mask:0xf
    v_dot2c_f32_bf16 v66, v102, v46
    v_add_f32_dpp v65, v65, v65 row_half_mirror row_mask:0xf bank_mask:0xf
    v_dot2c_f32_bf16 v66, v103, v47
    v_cvt_pk_bf16_f32 v65, v64, v65
    s_barrier
    s_xor_b32 s80, s75, 16
    v_mov_b32 v9, s80
    s_mov_b64 exec, 1
    buffer_store_dword v9, v5, s[76:79], s39 offen
    s_lshr_b32 s80, s7, 5
    s_lshl_b32 s80, s80, 8
    s_add_u32 s80, s80, 40960
    s_mov_b32 exec_lo, -1
    buffer_load_dword v254, v5, s[76:79], s80 offen sc1
    s_mov_b64 exec, -1
    s_nop 0
    s_add_u32 s10, s9, 0
    s_cmp_ge_u32 s10, s8
    s_cselect_b32 s83, 3145728, 0
    s_sub_u32 s10, s10, s83
    s_add_u32 s10, s10, 100663296
    s_waitcnt vmcnt(6)
    s_cmp_lt_u32 s38, 1
    s_cbranch_scc1 Lfb29
    s_waitcnt vmcnt(4)
    s_cmp_lt_u32 s38, 2
    s_cbranch_scc1 Lfb29
    s_waitcnt vmcnt(3)
Lfb29:
    buffer_load_dwordx4 v[84:87], v2, s[44:47], s10 offen offset:0 nt
    v_dot2c_f32_bf16 v66, v104, v48
    v_lshlrev_b32 v64, 16, v65
    v_dot2c_f32_bf16 v66, v105, v49
    v_and_b32 v65, s13, v65
    v_dot2c_f32_bf16 v66, v106, v50
    v_mul_f32 v64, s14, v64
    v_dot2c_f32_bf16 v66, v107, v51
    v_mul_f32 v65, s14, v65
    s_waitcnt vmcnt(5)
    s_cmp_lt_u32 s38, 1
    s_cbranch_scc1 Lfb30
    s_waitcnt vmcnt(4)
    s_cmp_lt_u32 s38, 2
    s_cbranch_scc1 Lfb30
    s_waitcnt vmcnt(3)
Lfb30:
    buffer_load_dwordx4 v[88:91], v2, s[44:47], s10 offen offset:128 nt
    v_mov_b32 v67, 0
    v_dot2c_f32_bf16 v67, v108, v40
    v_dot2c_f32_bf16 v67, v109, v41
    v_cvt_pk_bf16_f32 v65, v64, v65
    v_dot2c_f32_bf16 v67, v110, v42
    v_lshlrev_b32 v64, 16, v65
    v_dot2c_f32_bf16 v67, v111, v43
    v_and_b32 v65, s13, v65
    s_waitcnt vmcnt(5)
    s_cmp_lt_u32 s38, 1
    s_cbranch_scc1 Lfb31
    s_waitcnt vmcnt(4)
    s_cmp_lt_u32 s38, 2
    s_cbranch_scc1 Lfb31
    s_waitcnt vmcnt(1)
Lfb31:
    buffer_load_dwordx4 v[92:95], v2, s[44:47], s10 offen offset:256 nt
    v_dot2c_f32_bf16 v67, v112, v44
    v_max3_f32 v7, v7, v64, v65
    v_dot2c_f32_bf16 v67, v113, v45
    v_dot2c_f32_bf16 v67, v114, v46
    v_dot2c_f32_bf16 v67, v115, v47
    s_xor_b32 s80, s75, 17
    v_mov_b32 v9, s80
    s_mov_b64 exec, 1
    buffer_store_dword v9, v5, s[76:79], s39 offen
    s_mov_b64 exec, -1
    s_nop 0
    s_add_u32 s10, s9, 196608
    s_cmp_ge_u32 s10, s8
    s_cselect_b32 s83, 3145728, 0
    s_sub_u32 s10, s10, s83
    s_add_u32 s10, s10, 100663296
    s_waitcnt vmcnt(6)
    s_cmp_lt_u32 s38, 1
    s_cbranch_scc1 Lfb32
    s_waitcnt vmcnt(3)
    s_cmp_lt_u32 s38, 2
    s_cbranch_scc1 Lfb32
    s_waitcnt vmcnt(2)
Lfb32:
    buffer_load_dwordx4 v[96:99], v2, s[44:47], s10 offen offset:0 nt
    v_dot2c_f32_bf16 v67, v116, v48
    v_dot2c_f32_bf16 v67, v117, v49
    v_dot2c_f32_bf16 v67, v118, v50
    v_dot2c_f32_bf16 v67, v119, v51
    ds_read_b128 v[40:43], v6 offset:7040
    ds_read_b128 v[44:47], v6 offset:7168
    ds_read_b128 v[48:51], v6 offset:7296
    s_waitcnt vmcnt(4)
    s_cmp_lt_u32 s38, 1
    s_cbranch_scc1 Lfb33
    s_waitcnt vmcnt(3)
    s_cmp_lt_u32 s38, 2
    s_cbranch_scc1 Lfb33
    s_waitcnt vmcnt(2)
Lfb33:
    buffer_load_dwordx4 v[100:103], v2, s[44:47], s10 offen offset:128 nt
    v_xor_b32 v9, s75, v254
    v_min_u32 v9, 64, v9
    s_and_b32 s80, s7, 31
    s_nop 1
    v_readlane_b32 s81, v9, s80
    s_nop 1
    v_cmp_gt_u32 vcc, s81, v9
    s_nop 1
    s_bcnt1_i32_b32 s82, vcc_lo
    v_cmp_lt_u32 vcc, s81, v9
    s_nop 1
    s_bcnt1_i32_b32 s83, vcc_lo
    s_sub_i32 s82, s82, s83
    v_cmp_eq_u32 vcc, 64, v9
    s_nop 1
    s_bcnt1_i32_b32 s83, vcc_lo
    s_add_i32 s82, s82, s83
    s_cmp_gt_i32 s82, 99
    s_cselect_b32 s38, 2, 1
    s_cmp_lt_i32 s82, -4
    s_cselect_b32 s38, 0, s38
    s_waitcnt lgkmcnt(0)
    v_mov_b32 v68, 0
    v_dot2c_f32_bf16 v68, v84, v40
    v_dot2c_f32_bf16 v68, v85, v41
    v_add_f32_dpp v66, v66, v66 quad_perm:[1,0,3,2] row_mask:0xf bank_mask:0xf
    v_add_f32_dpp v67, v67, v67 quad_perm:[1,0,3,2] row_mask:0xf bank_mask:0xf
    s_nop 0
    v_add_f32_dpp v66, v66, v66 quad_perm:[2,3,0,1] row_mask:0xf bank_mask:0xf
    v_dot2c_f32_bf16 v68, v86, v42
    v_add_f32_dpp v67, v67, v67 quad_perm:[2,3,0,1] row_mask:0xf bank_mask:0xf
    v_add_f32_dpp v66, v66, v66 row_half_mirror row_mask:0xf bank_mask:0xf
    s_nop 0
    v_add_f32_dpp v67, v67, v67 row_half_mirror row_mask:0xf bank_mask:0xf
    v_dot2c_f32_bf16 v68, v87, v43
    v_cvt_pk_bf16_f32 v67, v66, v67
    v_lshlrev_b32 v66, 16, v67
    v_and_b32 v67, s13, v67
    s_waitcnt vmcnt(4)
    s_cmp_lt_u32 s38, 1
    s_cbranch_scc1 Lfb34
    s_waitcnt vmcnt(3)
    s_cmp_lt_u32 s38, 2
    s_cbranch_scc1 Lfb34
    s_waitcnt vmcnt(1)
Lfb34:
    buffer_load_dwordx4 v[104:107], v2, s[44:47], s10 offen offset:256 nt
    v_dot2c_f32_bf16 v68, v88, v44
    v_mul_f32 v66, s14, v66
    v_mul_f32 v67, s14, v67
    v_cvt_pk_bf16_f32 v67, v66, v67
    v_dot2c_f32_bf16 v68, v89, v45
    v_lshlrev_b32 v66, 16, v67
    v_and_b32 v67, s13, v67
    v_max3_f32 v7, v7, v66, v67
    v_dot2c_f32_bf16 v68, v90, v46
    s_nop 0
    v_max_f32_dpp v7, v7, v7 row_ror:8 row_mask:0xf bank_mask:0xf
    v_mov_b32 v14, v7
    s_nop 1
    v_permlane16_swap_b32 v7, v14
    v_dot2c_f32_bf16 v68, v91, v47
    v_max_f32 v7, v7, v14
    v_mov_b32 v14, v7
    s_nop 1
    v_permlane32_swap_b32 v7, v14
    s_barrier
    s_xor_b32 s80, s75, 18
    v_mov_b32 v9, s80
    s_mov_b64 exec, 1
    buffer_store_dword v9, v5, s[76:79], s39 offen
    s_lshr_b32 s80, s7, 5
    s_lshl_b32 s80, s80, 8
    s_add_u32 s80, s80, 40960
    s_mov_b32 exec_lo, -1
    buffer_load_dword v254, v5, s[76:79], s80 offen sc1
    s_mov_b64 exec, -1
    s_nop 0
    s_add_u32 s10, s9, 393216
    s_cmp_ge_u32 s10, s8
    s_cselect_b32 s83, 3145728, 0
    s_sub_u32 s10, s10, s83
    s_add_u32 s10, s10, 100663296
    s_waitcnt vmcnt(6)
    s_cmp_lt_u32 s38, 1
    s_cbranch_scc1 Lfb35
    s_waitcnt vmcnt(4)
    s_cmp_lt_u32 s38, 2
    s_cbranch_scc1 Lfb35
    s_waitcnt vmcnt(3)
Lfb35:
    buffer_load_dwordx4 v[108:111], v2, s[44:47], s10 offen offset:0 nt
    v_dot2c_f32_bf16 v68, v92, v48
    v_max_f32 v7, v7, v14
    v_mul_f32 v3, s15, v7
    v_fma_f32 v52, v52, s15, -v3
    v_dot2c_f32_bf16 v68, v93, v49
    v_fma_f32 v53, v53, s15, -v3
    v_fma_f32 v54, v54, s15, -v3
    v_fma_f32 v55, v55, s15, -v3
    v_dot2c_f32_bf16 v68, v94, v50
    v_exp_f32 v52, v52
    v_exp_f32 v53, v53
    v_exp_f32 v54, v54
    v_dot2c_f32_bf16 v68, v95, v51
    v_exp_f32 v55, v55
    v_mov_b32 v8, v52
    v_add_f32 v8, v8, v53
    s_waitcnt vmcnt(5)
    s_cmp_lt_u32 s38, 1
    s_cbranch_scc1 Lfb36
    s_waitcnt vmcnt(4)
    s_cmp_lt_u32 s38, 2
    s_cbranch_scc1 Lfb36
    s_waitcnt vmcnt(3)
Lfb36:
    buffer_load_dwordx4 v[112:115], v2, s[44:47], s10 offen offset:128 nt
    v_mov_b32 v69, 0
    v_dot2c_f32_bf16 v69, v96, v40
    v_dot2c_f32_bf16 v69, v97, v41
    v_add_f32 v8, v8, v54
    v_add_f32 v8, v8, v55
    v_cvt_pk_bf16_f32 v52, v52, 0
    v_dot2c_f32_bf16 v69, v98, v42
    v_cvt_pk_bf16_f32 v53, v53, 0
    v_cvt_pk_bf16_f32 v54, v54, 0
    v_cvt_pk_bf16_f32 v55, v55, 0
    v_dot2c_f32_bf16 v69, v99, v43
    v_fma_f32 v56, v56, s15, -v3
    v_fma_f32 v57, v57, s15, -v3
    v_fma_f32 v58, v58, s15, -v3
    s_waitcnt vmcnt(5)
    s_cmp_lt_u32 s38, 1
    s_cbranch_scc1 Lfb37
    s_waitcnt vmcnt(4)
    s_cmp_lt_u32 s38, 2
    s_cbranch_scc1 Lfb37
    s_waitcnt vmcnt(1)
Lfb37:
    buffer_load_dwordx4 v[116:119], v2, s[44:47], s10 offen offset:256 nt
    v_dot2c_f32_bf16 v69, v100, v44
    v_fma_f32 v59, v59, s15, -v3
    v_exp_f32 v56, v56
    v_exp_f32 v57, v57
    v_dot2c_f32_bf16 v69, v101, v45
    v_exp_f32 v58, v58
    v_exp_f32 v59, v59
    v_add_f32 v8, v8, v56
    v_dot2c_f32_bf16 v69, v102, v46
    v_add_f32 v8, v8, v57
    v_add_f32 v8, v8, v58
    v_add_f32 v8, v8, v59
    v_dot2c_f32_bf16 v69, v103, v47
    v_cvt_pk_bf16_f32 v56, v56, 0
    v_cvt_pk_bf16_f32 v57, v57, 0
    v_cvt_pk_bf16_f32 v58, v58, 0
    s_add_u32 s10, s12, 0
    buffer_load_dwordx4 v[242:245], v4, s[56:59], s10 offen offset:0
    buffer_load_dword v250, v5, s[56:59], s10 offen offset:1024
    buffer_load_dwordx4 v[246:249], v4, s[56:59], s10 offen offset:1280
    buffer_load_dword v251, v5, s[56:59], s10 offen offset:2304
    s_xor_b32 s80, s75, 19
    v_mov_b32 v9, s80
    s_mov_b64 exec, 1
    buffer_store_dword v9, v5, s[76:79], s39 offen
    s_mov_b64 exec, -1
    s_nop 0
    s_add_u32 s10, s9, 589824
    s_cmp_ge_u32 s10, s8
    s_cselect_b32 s83, 3145728, 0
    s_sub_u32 s10, s10, s83
    s_add_u32 s10, s10, 100663296
    s_waitcnt vmcnt(10)
    s_cmp_lt_u32 s38, 1
    s_cbranch_scc1 Lfb38
    s_waitcnt vmcnt(7)
    s_cmp_lt_u32 s38, 2
    s_cbranch_scc1 Lfb38
    s_waitcnt vmcnt(6)
Lfb38:
    buffer_load_dwordx4 v[84:87], v2, s[44:47], s10 offen offset:0 nt
    v_dot2c_f32_bf16 v69, v104, v48
    v_cvt_pk_bf16_f32 v59, v59, 0
    v_fma_f32 v60, v60, s15, -v3
    v_fma_f32 v61, v61, s15, -v3
    v_dot2c_f32_bf16 v69, v105, v49
    v_fma_f32 v62, v62, s15, -v3
    v_fma_f32 v63, v63, s15, -v3
    v_exp_f32 v60, v60
    v_dot2c_f32_bf16 v69, v106, v50
    v_exp_f32 v61, v61
    v_exp_f32 v62, v62
    v_exp_f32 v63, v63
    v_dot2c_f32_bf16 v69, v107, v51
    v_add_f32 v8, v8, v60
    v_add_f32 v8, v8, v61
    v_add_f32 v8, v8, v62
    s_waitcnt vmcnt(8)
    s_cmp_lt_u32 s38, 1
    s_cbranch_scc1 Lfb39
    s_waitcnt vmcnt(7)
    s_cmp_lt_u32 s38, 2
    s_cbranch_scc1 Lfb39
    s_waitcnt vmcnt(6)
Lfb39:
    buffer_load_dwordx4 v[88:91], v2, s[44:47], s10 offen offset:128 nt
    v_xor_b32 v9, s75, v254
    v_min_u32 v9, 64, v9
    s_and_b32 s80, s7, 31
    s_nop 1
    v_readlane_b32 s81, v9, s80
    s_nop 1
    v_cmp_gt_u32 vcc, s81, v9
    s_nop 1
    s_bcnt1_i32_b32 s82, vcc_lo
    v_cmp_lt_u32 vcc, s81, v9
    s_nop 1
    s_bcnt1_i32_b32 s83, vcc_lo
    s_sub_i32 s82, s82, s83
    v_cmp_eq_u32 vcc, 64, v9
    s_nop 1
    s_bcnt1_i32_b32 s83, vcc_lo
    s_add_i32 s82, s82, s83
    s_cmp_gt_i32 s82, 99
    s_cselect_b32 s38, 2, 1
    s_cmp_lt_i32 s82, -4
    s_cselect_b32 s38, 0, s38
    v_mov_b32 v70, 0
    v_dot2c_f32_bf16 v70, v108, v40
    v_dot2c_f32_bf16 v70, v109, v41
    v_add_f32 v8, v8, v63
    v_cvt_pk_bf16_f32 v60, v60, 0
    v_cvt_pk_bf16_f32 v61, v61, 0
    v_dot2c_f32_bf16 v70, v110, v42
    v_cvt_pk_bf16_f32 v62, v62, 0
    v_cvt_pk_bf16_f32 v63, v63, 0
    v_fma_f32 v64, v64, s15, -v3
    v_dot2c_f32_bf16 v70, v111, v43
    v_fma_f32 v65, v65, s15, -v3
    v_fma_f32 v66, v66, s15, -v3
    v_fma_f32 v67, v67, s15, -v3
    s_waitcnt vmcnt(8)
    s_cmp_lt_u32 s38, 1
    s_cbranch_scc1 Lfb40
    s_waitcnt vmcnt(7)
    s_cmp_lt_u32 s38, 2
    s_cbranch_scc1 Lfb40
    s_waitcnt vmcnt(1)
Lfb40:
    buffer_load_dwordx4 v[92:95], v2, s[44:47], s10 offen offset:256 nt
    v_dot2c_f32_bf16 v70, v112, v44
    v_exp_f32 v64, v64
    v_exp_f32 v65, v65
    v_exp_f32 v66, v66
    v_dot2c_f32_bf16 v70, v113, v45
    v_exp_f32 v67, v67
    v_add_f32 v8, v8, v64
    v_add_f32 v8, v8, v65
    v_dot2c_f32_bf16 v70, v114, v46
    v_add_f32 v8, v8, v66
    v_add_f32 v8, v8, v67
    v_cvt_pk_bf16_f32 v64, v64, 0
    v_dot2c_f32_bf16 v70, v115, v47
    v_cvt_pk_bf16_f32 v65, v65, 0
    v_cvt_pk_bf16_f32 v66, v66, 0
    v_cvt_pk_bf16_f32 v67, v67, 0
    s_barrier
    s_xor_b32 s80, s75, 20
    v_mov_b32 v9, s80
    s_mov_b64 exec, 1
    buffer_store_dword v9, v5, s[76:79], s39 offen
    s_lshr_b32 s80, s7, 5
    s_lshl_b32 s80, s80, 8
    s_add_u32 s80, s80, 40960
    s_mov_b32 exec_lo, -1
    buffer_load_dword v254, v5, s[76:79], s80 offen sc1
    s_mov_b64 exec, -1
    s_nop 0
    s_add_u32 s10, s9, 786432
    s_cmp_ge_u32 s10, s8
    s_cselect_b32 s83, 3145728, 0
    s_sub_u32 s10, s10, s83
    s_add_u32 s10, s10, 100663296
    s_waitcnt vmcnt(10)
    s_cmp_lt_u32 s38, 1
    s_cbranch_scc1 Lfb41
    s_waitcnt vmcnt(4)
    s_cmp_lt_u32 s38, 2
    s_cbranch_scc1 Lfb41
    s_waitcnt vmcnt(3)
Lfb41:
    buffer_load_dwordx4 v[96:99], v2, s[44:47], s10 offen offset:0 nt
    v_dot2c_f32_bf16 v70, v116, v48
    v_add_f32_dpp v8, v8, v8 row_ror:8 row_mask:0xf bank_mask:0xf
    v_mov_b32 v14, v8
    s_nop 1
    v_permlane16_swap_b32 v8, v14
    v_dot2c_f32_bf16 v70, v117, v49
    v_add_f32 v8, v8, v14
    v_mov_b32 v14, v8
    s_nop 1
    v_permlane32_swap_b32 v8, v14
    v_dot2c_f32_bf16 v70, v118, v50
    v_add_f32 v8, v8, v14
    v_lshlrev_b32_e64 v14, 3, s3
    ds_write_b32 v14, v7 offset:8960
    v_dot2c_f32_bf16 v70, v119, v51
    ds_write_b32 v14, v8 offset:8964
    s_waitcnt vmcnt(5)
    s_cmp_lt_u32 s38, 1
    s_cbranch_scc1 Lfb42
    s_waitcnt vmcnt(4)
    s_cmp_lt_u32 s38, 2
    s_cbranch_scc1 Lfb42
    s_waitcnt vmcnt(3)
Lfb42:
    buffer_load_dwordx4 v[100:103], v2, s[44:47], s10 offen offset:128 nt
    v_mov_b32 v71, 0
    v_dot2c_f32_bf16 v71, v84, v40
    v_dot2c_f32_bf16 v71, v85, v41
    v_mov_b32 v7, 0xff800000
    v_dot2c_f32_bf16 v71, v86, v42
    v_add_f32_dpp v68, v68, v68 quad_perm:[1,0,3,2] row_mask:0xf bank_mask:0xf
    v_dot2c_f32_bf16 v71, v87, v43
    v_add_f32_dpp v69, v69, v69 quad_perm:[1,0,3,2] row_mask:0xf bank_mask:0xf
    v_perm_b32 v252, v246, v242, s20
    v_perm_b32 v246, v246, v242, s21
    v_perm_b32 v242, v247, v243, s20
    v_perm_b32 v247, v247, v243, s21
    v_perm_b32 v243, v248, v244, s20
    v_perm_b32 v248, v248, v244, s21
    v_perm_b32 v244, v249, v245, s20
    v_perm_b32 v249, v249, v245, s21
    v_perm_b32 v245, v251, v250, s20
    v_perm_b32 v251, v251, v250, s21
    v_mov_b32 v250, v252
    s_waitcnt vmcnt(5)
    s_cmp_lt_u32 s38, 1
    s_cbranch_scc1 Lfb43
    s_waitcnt vmcnt(4)
    s_cmp_lt_u32 s38, 2
    s_cbranch_scc1 Lfb43
    s_waitcnt vmcnt(1)
Lfb43:
    buffer_load_dwordx4 v[104:107], v2, s[44:47], s10 offen offset:256 nt
    v_dot2c_f32_bf16 v71, v88, v44
    v_add_f32_dpp v68, v68, v68 quad_perm:[2,3,0,1] row_mask:0xf bank_mask:0xf
    v_dot2c_f32_bf16 v71, v89, v45
    v_add_f32_dpp v69, v69, v69 quad_perm:[2,3,0,1] row_mask:0xf bank_mask:0xf
    v_dot2c_f32_bf16 v71, v90, v46
    v_add_f32_dpp v68, v68, v68 row_half_mirror row_mask:0xf bank_mask:0xf
    v_dot2c_f32_bf16 v71, v91, v47
    v_add_f32_dpp v69, v69, v69 row_half_mirror row_mask:0xf bank_mask:0xf
    s_add_u32 s10, s12, 2560
    buffer_load_dwordx4 v[232:235], v4, s[56:59], s10 offen offset:0
    buffer_load_dword v240, v5, s[56:59], s10 offen offset:1024
    buffer_load_dwordx4 v[236:239], v4, s[56:59], s10 offen offset:1280
    buffer_load_dword v241, v5, s[56:59], s10 offen offset:2304
    s_xor_b32 s80, s75, 21
    v_mov_b32 v9, s80
    s_mov_b64 exec, 1
    buffer_store_dword v9, v5, s[76:79], s39 offen
    s_mov_b64 exec, -1
    s_nop 0
    s_add_u32 s10, s9, 983040
    s_cmp_ge_u32 s10, s8
    s_cselect_b32 s83, 3145728, 0
    s_sub_u32 s10, s10, s83
    s_add_u32 s10, s10, 100663296
    s_waitcnt vmcnt(10)
    s_cmp_lt_u32 s38, 1
    s_cbranch_scc1 Lfb44
    s_waitcnt vmcnt(7)
    s_cmp_lt_u32 s38, 2
    s_cbranch_scc1 Lfb44
    s_waitcnt vmcnt(6)
Lfb44:
    buffer_load_dwordx4 v[108:111], v2, s[44:47], s10 offen offset:0 nt
    v_dot2c_f32_bf16 v71, v92, v48
    v_cvt_pk_bf16_f32 v69, v68, v69
    v_dot2c_f32_bf16 v71, v93, v49
    v_lshlrev_b32 v68, 16, v69
    v_dot2c_f32_bf16 v71, v94, v50
    v_and_b32 v69, s13, v69
    v_dot2c_f32_bf16 v71, v95, v51
    v_mul_f32 v68, s14, v68
    s_waitcnt vmcnt(8)
    s_cmp_lt_u32 s38, 1
    s_cbranch_scc1 Lfb45
    s_waitcnt vmcnt(7)
    s_cmp_lt_u32 s38, 2
    s_cbranch_scc1 Lfb45
    s_waitcnt vmcnt(6)
Lfb45:
    buffer_load_dwordx4 v[112:115], v2, s[44:47], s10 offen offset:128 nt
    v_xor_b32 v9, s75, v254
    v_min_u32 v9, 64, v9
    s_and_b32 s80, s7, 31
    s_nop 1
    v_readlane_b32 s81, v9, s80
    s_nop 1
    v_cmp_gt_u32 vcc, s81, v9
    s_nop 1
    s_bcnt1_i32_b32 s82, vcc_lo
    v_cmp_lt_u32 vcc, s81, v9
    s_nop 1
    s_bcnt1_i32_b32 s83, vcc_lo
    s_sub_i32 s82, s82, s83
    v_cmp_eq_u32 vcc, 64, v9
    s_nop 1
    s_bcnt1_i32_b32 s83, vcc_lo
    s_add_i32 s82, s82, s83
    s_cmp_gt_i32 s82, 99
    s_cselect_b32 s38, 2, 1
    s_cmp_lt_i32 s82, -4
    s_cselect_b32 s38, 0, s38
    v_mov_b32 v72, 0
    v_dot2c_f32_bf16 v72, v96, v40
    v_dot2c_f32_bf16 v72, v97, v41
    v_mul_f32 v69, s14, v69
    v_cvt_pk_bf16_f32 v69, v68, v69
    v_lshlrev_b32 v68, 16, v69
    v_dot2c_f32_bf16 v72, v98, v42
    v_and_b32 v69, s13, v69
    v_dot2c_f32_bf16 v72, v99, v43
    v_max3_f32 v7, v7, v68, v69
    s_waitcnt vmcnt(8)
    s_cmp_lt_u32 s38, 1
    s_cbranch_scc1 Lfb46
    s_waitcnt vmcnt(7)
    s_cmp_lt_u32 s38, 2
    s_cbranch_scc1 Lfb46
    s_waitcnt vmcnt(1)
Lfb46:
    buffer_load_dwordx4 v[116:119], v2, s[44:47], s10 offen offset:256 nt
    v_dot2c_f32_bf16 v72, v100, v44
    v_add_f32_dpp v70, v70, v70 quad_perm:[1,0,3,2] row_mask:0xf bank_mask:0xf
    v_dot2c_f32_bf16 v72, v101, v45
    v_add_f32_dpp v71, v71, v71 quad_perm:[1,0,3,2] row_mask:0xf bank_mask:0xf
    v_dot2c_f32_bf16 v72, v102, v46
    v_add_f32_dpp v70, v70, v70 quad_perm:[2,3,0,1] row_mask:0xf bank_mask:0xf
    v_dot2c_f32_bf16 v72, v103, v47
    v_add_f32_dpp v71, v71, v71 quad_perm:[2,3,0,1] row_mask:0xf bank_mask:0xf
    s_barrier
    s_xor_b32 s80, s75, 22
    v_mov_b32 v9, s80
    s_mov_b64 exec, 1
    buffer_store_dword v9, v5, s[76:79], s39 offen
    s_lshr_b32 s80, s7, 5
    s_lshl_b32 s80, s80, 8
    s_add_u32 s80, s80, 40960
    s_mov_b32 exec_lo, -1
    buffer_load_dword v254, v5, s[76:79], s80 offen sc1
    s_mov_b64 exec, -1
    s_nop 0
    s_add_u32 s10, s9, 1179648
    s_cmp_ge_u32 s10, s8
    s_cselect_b32 s83, 3145728, 0
    s_sub_u32 s10, s10, s83
    s_add_u32 s10, s10, 100663296
    s_waitcnt vmcnt(10)
    s_cmp_lt_u32 s38, 1
    s_cbranch_scc1 Lfb47
    s_waitcnt vmcnt(4)
    s_cmp_lt_u32 s38, 2
    s_cbranch_scc1 Lfb47
    s_waitcnt vmcnt(3)
Lfb47:
    buffer_load_dwordx4 v[84:87], v2, s[44:47], s10 offen offset:0 nt
    v_dot2c_f32_bf16 v72, v104, v48
    v_add_f32_dpp v70, v70, v70 row_half_mirror row_mask:0xf bank_mask:0xf
    v_dot2c_f32_bf16 v72, v105, v49
    v_add_f32_dpp v71, v71, v71 row_half_mirror row_mask:0xf bank_mask:0xf
    v_dot2c_f32_bf16 v72, v106, v50
    v_cvt_pk_bf16_f32 v71, v70, v71
    v_dot2c_f32_bf16 v72, v107, v51
    v_lshlrev_b32 v70, 16, v71
    s_waitcnt vmcnt(5)
    s_cmp_lt_u32 s38, 1
    s_cbranch_scc1 Lfb48
    s_waitcnt vmcnt(4)
    s_cmp_lt_u32 s38, 2
    s_cbranch_scc1 Lfb48
    s_waitcnt vmcnt(3)
Lfb48:
    buffer_load_dwordx4 v[88:91], v2, s[44:47], s10 offen offset:128 nt
    v_mov_b32 v73, 0
    v_dot2c_f32_bf16 v73, v108, v40
    v_dot2c_f32_bf16 v73, v109, v41
    v_and_b32 v71, s13, v71
    v_dot2c_f32_bf16 v73, v110, v42
    v_mul_f32 v70, s14, v70
    v_dot2c_f32_bf16 v73, v111, v43
    v_mul_f32 v71, s14, v71
    v_perm_b32 v252, v236, v232, s20
    v_perm_b32 v236, v236, v232, s21
    v_perm_b32 v232, v237, v233, s20
    v_perm_b32 v237, v237, v233, s21
    v_perm_b32 v233, v238, v234, s20
    v_perm_b32 v238, v238, v234, s21
    v_perm_b32 v234, v239, v235, s20
    v_perm_b32 v239, v239, v235, s21
    v_perm_b32 v235, v241, v240, s20
    v_perm_b32 v241, v241, v240, s21
    v_mov_b32 v240, v252
    s_waitcnt vmcnt(5)
    s_cmp_lt_u32 s38, 1
    s_cbranch_scc1 Lfb49
    s_waitcnt vmcnt(4)
    s_cmp_lt_u32 s38, 2
    s_cbranch_scc1 Lfb49
    s_waitcnt vmcnt(1)
Lfb49:
    buffer_load_dwordx4 v[92:95], v2, s[44:47], s10 offen offset:256 nt
    v_dot2c_f32_bf16 v73, v112, v44
    v_cvt_pk_bf16_f32 v71, v70, v71
    v_dot2c_f32_bf16 v73, v113, v45
    v_lshlrev_b32 v70, 16, v71
    v_dot2c_f32_bf16 v73, v114, v46
    v_and_b32 v71, s13, v71
    v_dot2c_f32_bf16 v73, v115, v47
    v_max3_f32 v7, v7, v70, v71
    s_add_u32 s10, s12, 5120
    buffer_load_dwordx4 v[222:225], v4, s[56:59], s10 offen offset:0
    buffer_load_dword v230, v5, s[56:59], s10 offen offset:1024
    buffer_load_dwordx4 v[226:229], v4, s[56:59], s10 offen offset:1280
    buffer_load_dword v231, v5, s[56:59], s10 offen offset:2304
    s_xor_b32 s80, s75, 23
    v_mov_b32 v9, s80
    s_mov_b64 exec, 1
    buffer_store_dword v9, v5, s[76:79], s39 offen
    s_mov_b64 exec, -1
    s_nop 0
    s_add_u32 s10, s9, 1376256
    s_cmp_ge_u32 s10, s8
    s_cselect_b32 s83, 3145728, 0
    s_sub_u32 s10, s10, s83
    s_add_u32 s10, s10, 100663296
    s_waitcnt vmcnt(10)
    s_cmp_lt_u32 s38, 1
    s_cbranch_scc1 Lfb50
    s_waitcnt vmcnt(7)
    s_cmp_lt_u32 s38, 2
    s_cbranch_scc1 Lfb50
    s_waitcnt vmcnt(6)
Lfb50:
    buffer_load_dwordx4 v[96:99], v2, s[44:47], s10 offen offset:0 nt
    v_dot2c_f32_bf16 v73, v116, v48
    v_dot2c_f32_bf16 v73, v117, v49
    v_dot2c_f32_bf16 v73, v118, v50
    v_dot2c_f32_bf16 v73, v119, v51
    s_waitcnt vmcnt(8)
    s_cmp_lt_u32 s38, 1
    s_cbranch_scc1 Lfb51
    s_waitcnt vmcnt(7)
    s_cmp_lt_u32 s38, 2
    s_cbranch_scc1 Lfb51
    s_waitcnt vmcnt(6)
Lfb51:
    buffer_load_dwordx4 v[100:103], v2, s[44:47], s10 offen offset:128 nt
    v_xor_b32 v9, s75, v254
    v_min_u32 v9, 64, v9
    s_and_b32 s80, s7, 31
    s_nop 1
    v_readlane_b32 s81, v9, s80
    s_nop 1
    v_cmp_gt_u32 vcc, s81, v9
    s_nop 1
    s_bcnt1_i32_b32 s82, vcc_lo
    v_cmp_lt_u32 vcc, s81, v9
    s_nop 1
    s_bcnt1_i32_b32 s83, vcc_lo
    s_sub_i32 s82, s82, s83
    v_cmp_eq_u32 vcc, 64, v9
    s_nop 1
    s_bcnt1_i32_b32 s83, vcc_lo
    s_add_i32 s82, s82, s83
    s_cmp_gt_i32 s82, 99
    s_cselect_b32 s38, 2, 1
    s_cmp_lt_i32 s82, -4
    s_cselect_b32 s38, 0, s38
    v_mov_b32 v74, 0
    v_dot2c_f32_bf16 v74, v84, v40
    v_dot2c_f32_bf16 v74, v85, v41
    v_add_f32_dpp v72, v72, v72 quad_perm:[1,0,3,2] row_mask:0xf bank_mask:0xf
    v_dot2c_f32_bf16 v74, v86, v42
    v_add_f32_dpp v73, v73, v73 quad_perm:[1,0,3,2] row_mask:0xf bank_mask:0xf
    v_dot2c_f32_bf16 v74, v87, v43
    v_add_f32_dpp v72, v72, v72 quad_perm:[2,3,0,1] row_mask:0xf bank_mask:0xf
    s_waitcnt vmcnt(8)
    s_cmp_lt_u32 s38, 1
    s_cbranch_scc1 Lfb52
    s_waitcnt vmcnt(7)
    s_cmp_lt_u32 s38, 2
    s_cbranch_scc1 Lfb52
    s_waitcnt vmcnt(1)
Lfb52:
    buffer_load_dwordx4 v[104:107], v2, s[44:47], s10 offen offset:256 nt
    v_dot2c_f32_bf16 v74, v88, v44
    v_add_f32_dpp v73, v73, v73 quad_perm:[2,3,0,1] row_mask:0xf bank_mask:0xf
    v_dot2c_f32_bf16 v74, v89, v45
    v_add_f32_dpp v72, v72, v72 row_half_mirror row_mask:0xf bank_mask:0xf
    v_dot2c_f32_bf16 v74, v90, v46
    v_add_f32_dpp v73, v73, v73 row_half_mirror row_mask:0xf bank_mask:0xf
    v_dot2c_f32_bf16 v74, v91, v47
    v_cvt_pk_bf16_f32 v73, v72, v73
    s_barrier
    s_xor_b32 s80, s75, 24
    v_mov_b32 v9, s80
    s_mov_b64 exec, 1
    buffer_store_dword v9, v5, s[76:79], s39 offen
    s_lshr_b32 s80, s7, 5
    s_lshl_b32 s80, s80, 8
    s_add_u32 s80, s80, 40960
    s_mov_b32 exec_lo, -1
    buffer_load_dword v254, v5, s[76:79], s80 offen sc1
    s_mov_b64 exec, -1
    s_nop 0
    s_add_u32 s10, s9, 1572864
    s_cmp_ge_u32 s10, s8
    s_cselect_b32 s83, 3145728, 0
    s_sub_u32 s10, s10, s83
    s_add_u32 s10, s10, 100663296
    s_waitcnt vmcnt(10)
    s_cmp_lt_u32 s38, 1
    s_cbranch_scc1 Lfb53
    s_waitcnt vmcnt(4)
    s_cmp_lt_u32 s38, 2
    s_cbranch_scc1 Lfb53
    s_waitcnt vmcnt(3)
Lfb53:
    buffer_load_dwordx4 v[108:111], v2, s[44:47], s10 offen offset:0 nt
    v_dot2c_f32_bf16 v74, v92, v48
    v_lshlrev_b32 v72, 16, v73
    v_dot2c_f32_bf16 v74, v93, v49
    v_and_b32 v73, s13, v73
    v_dot2c_f32_bf16 v74, v94, v50
    v_mul_f32 v72, s14, v72
    v_dot2c_f32_bf16 v74, v95, v51
    v_mul_f32 v73, s14, v73
    s_waitcnt vmcnt(5)
    s_cmp_lt_u32 s38, 1
    s_cbranch_scc1 Lfb54
    s_waitcnt vmcnt(4)
    s_cmp_lt_u32 s38, 2
    s_cbranch_scc1 Lfb54
    s_waitcnt vmcnt(3)
Lfb54:
    buffer_load_dwordx4 v[112:115], v2, s[44:47], s10 offen offset:128 nt
    v_mov_b32 v75, 0
    v_dot2c_f32_bf16 v75, v96, v40
    v_dot2c_f32_bf16 v75, v97, v41
    v_cvt_pk_bf16_f32 v73, v72, v73
    v_dot2c_f32_bf16 v75, v98, v42
    v_lshlrev_b32 v72, 16, v73
    v_dot2c_f32_bf16 v75, v99, v43
    v_and_b32 v73, s13, v73
    v_perm_b32 v252, v226, v222, s20
    v_perm_b32 v226, v226, v222, s21
    v_perm_b32 v222, v227, v223, s20
    v_perm_b32 v227, v227, v223, s21
    v_perm_b32 v223, v228, v224, s20
    v_perm_b32 v228, v228, v224, s21
    v_perm_b32 v224, v229, v225, s20
    v_perm_b32 v229, v229, v225, s21
    v_perm_b32 v225, v231, v230, s20
    v_perm_b32 v231, v231, v230, s21
    v_mov_b32 v230, v252
    s_waitcnt vmcnt(5)
    s_cmp_lt_u32 s38, 1
    s_cbranch_scc1 Lfb55
    s_waitcnt vmcnt(4)
    s_cmp_lt_u32 s38, 2
    s_cbranch_scc1 Lfb55
    s_waitcnt vmcnt(1)
Lfb55:
    buffer_load_dwordx4 v[116:119], v2, s[44:47], s10 offen offset:256 nt
    v_dot2c_f32_bf16 v75, v100, v44
    v_max3_f32 v7, v7, v72, v73
    v_dot2c_f32_bf16 v75, v101, v45
    v_dot2c_f32_bf16 v75, v102, v46
    v_dot2c_f32_bf16 v75, v103, v47
    s_add_u32 s10, s12, 7680
    buffer_load_dwordx4 v[212:215], v4, s[56:59], s10 offen offset:0
    buffer_load_dword v220, v5, s[56:59], s10 offen offset:1024
    buffer_load_dwordx4 v[216:219], v4, s[56:59], s10 offen offset:1280
    buffer_load_dword v221, v5, s[56:59], s10 offen offset:2304
    s_xor_b32 s80, s75, 25
    v_mov_b32 v9, s80
    s_mov_b64 exec, 1
    buffer_store_dword v9, v5, s[76:79], s39 offen
    s_mov_b64 exec, -1
    s_nop 0
    s_add_u32 s10, s9, 1769472
    s_cmp_ge_u32 s10, s8
    s_cselect_b32 s83, 3145728, 0
    s_sub_u32 s10, s10, s83
    s_add_u32 s10, s10, 100663296
    s_waitcnt vmcnt(10)
    s_cmp_lt_u32 s38, 1
    s_cbranch_scc1 Lfb56
    s_waitcnt vmcnt(7)
    s_cmp_lt_u32 s38, 2
    s_cbranch_scc1 Lfb56
    s_waitcnt vmcnt(6)
Lfb56:
    buffer_load_dwordx4 v[84:87], v2, s[44:47], s10 offen offset:0 nt
    v_dot2c_f32_bf16 v75, v104, v48
    v_dot2c_f32_bf16 v75, v105, v49
    v_dot2c_f32_bf16 v75, v106, v50
    v_dot2c_f32_bf16 v75, v107, v51
    s_waitcnt vmcnt(8)
    s_cmp_lt_u32 s38, 1
    s_cbranch_scc1 Lfb57
    s_waitcnt vmcnt(7)
    s_cmp_lt_u32 s38, 2
    s_cbranch_scc1 Lfb57
    s_waitcnt vmcnt(6)
Lfb57:
    buffer_load_dwordx4 v[88:91], v2, s[44:47], s10 offen offset:128 nt
    v_xor_b32 v9, s75, v254
    v_min_u32 v9, 64, v9
    s_and_b32 s80, s7, 31
    s_nop 1
    v_readlane_b32 s81, v9, s80
    s_nop 1
    v_cmp_gt_u32 vcc, s81, v9
    s_nop 1
    s_bcnt1_i32_b32 s82, vcc_lo
    v_cmp_lt_u32 vcc, s81, v9
    s_nop 1
    s_bcnt1_i32_b32 s83, vcc_lo
    s_sub_i32 s82, s82, s83
    v_cmp_eq_u32 vcc, 64, v9
    s_nop 1
    s_bcnt1_i32_b32 s83, vcc_lo
    s_add_i32 s82, s82, s83
    s_cmp_gt_i32 s82, 99
    s_cselect_b32 s38, 2, 1
    s_cmp_lt_i32 s82, -4
    s_cselect_b32 s38, 0, s38
    v_mov_b32 v76, 0
    v_dot2c_f32_bf16 v76, v108, v40
    v_dot2c_f32_bf16 v76, v109, v41
    v_add_f32_dpp v74, v74, v74 quad_perm:[1,0,3,2] row_mask:0xf bank_mask:0xf
    v_dot2c_f32_bf16 v76, v110, v42
    v_add_f32_dpp v75, v75, v75 quad_perm:[1,0,3,2] row_mask:0xf bank_mask:0xf
    v_dot2c_f32_bf16 v76, v111, v43
    v_add_f32_dpp v74, v74, v74 quad_perm:[2,3,0,1] row_mask:0xf bank_mask:0xf
    s_waitcnt vmcnt(8)
    s_cmp_lt_u32 s38, 1
    s_cbranch_scc1 Lfb58
    s_waitcnt vmcnt(7)
    s_cmp_lt_u32 s38, 2
    s_cbranch_scc1 Lfb58
    s_waitcnt vmcnt(1)
Lfb58:
    buffer_load_dwordx4 v[92:95], v2, s[44:47], s10 offen offset:256 nt
    v_dot2c_f32_bf16 v76, v112, v44
    v_add_f32_dpp v75, v75, v75 quad_perm:[2,3,0,1] row_mask:0xf bank_mask:0xf
    v_dot2c_f32_bf16 v76, v113, v45
    v_add_f32_dpp v74, v74, v74 row_half_mirror row_mask:0xf bank_mask:0xf
    v_dot2c_f32_bf16 v76, v114, v46
    v_add_f32_dpp v75, v75, v75 row_half_mirror row_mask:0xf bank_mask:0xf
    v_dot2c_f32_bf16 v76, v115, v47
    v_cvt_pk_bf16_f32 v75, v74, v75
    s_barrier
    s_xor_b32 s80, s75, 26
    v_mov_b32 v9, s80
    s_mov_b64 exec, 1
    buffer_store_dword v9, v5, s[76:79], s39 offen
    s_lshr_b32 s80, s7, 5
    s_lshl_b32 s80, s80, 8
    s_add_u32 s80, s80, 40960
    s_mov_b32 exec_lo, -1
    buffer_load_dword v254, v5, s[76:79], s80 offen sc1
    s_mov_b64 exec, -1
    s_nop 0
    s_add_u32 s10, s9, 1966080
    s_cmp_ge_u32 s10, s8
    s_cselect_b32 s83, 3145728, 0
    s_sub_u32 s10, s10, s83
    s_add_u32 s10, s10, 100663296
    s_waitcnt vmcnt(10)
    s_cmp_lt_u32 s38, 1
    s_cbranch_scc1 Lfb59
    s_waitcnt vmcnt(4)
    s_cmp_lt_u32 s38, 2
    s_cbranch_scc1 Lfb59
    s_waitcnt vmcnt(3)
Lfb59:
    buffer_load_dwordx4 v[96:99], v2, s[44:47], s10 offen offset:0 nt
    v_dot2c_f32_bf16 v76, v116, v48
    v_lshlrev_b32 v74, 16, v75
    v_dot2c_f32_bf16 v76, v117, v49
    v_and_b32 v75, s13, v75
    v_dot2c_f32_bf16 v76, v118, v50
    v_mul_f32 v74, s14, v74
    v_dot2c_f32_bf16 v76, v119, v51
    v_mul_f32 v75, s14, v75
    s_waitcnt vmcnt(5)
    s_cmp_lt_u32 s38, 1
    s_cbranch_scc1 Lfb60
    s_waitcnt vmcnt(4)
    s_cmp_lt_u32 s38, 2
    s_cbranch_scc1 Lfb60
    s_waitcnt vmcnt(3)
Lfb60:
    buffer_load_dwordx4 v[100:103], v2, s[44:47], s10 offen offset:128 nt
    v_mov_b32 v77, 0
    v_dot2c_f32_bf16 v77, v84, v40
    v_dot2c_f32_bf16 v77, v85, v41
    v_cvt_pk_bf16_f32 v75, v74, v75
    v_dot2c_f32_bf16 v77, v86, v42
    v_lshlrev_b32 v74, 16, v75
    v_dot2c_f32_bf16 v77, v87, v43
    v_and_b32 v75, s13, v75
    v_perm_b32 v252, v216, v212, s20
    v_perm_b32 v216, v216, v212, s21
    v_perm_b32 v212, v217, v213, s20
    v_perm_b32 v217, v217, v213, s21
    v_perm_b32 v213, v218, v214, s20
    v_perm_b32 v218, v218, v214, s21
    v_perm_b32 v214, v219, v215, s20
    v_perm_b32 v219, v219, v215, s21
    v_perm_b32 v215, v221, v220, s20
    v_perm_b32 v221, v221, v220, s21
    v_mov_b32 v220, v252
    s_waitcnt vmcnt(5)
    s_cmp_lt_u32 s38, 1
    s_cbranch_scc1 Lfb61
    s_waitcnt vmcnt(4)
    s_cmp_lt_u32 s38, 2
    s_cbranch_scc1 Lfb61
    s_waitcnt vmcnt(1)
Lfb61:
    buffer_load_dwordx4 v[104:107], v2, s[44:47], s10 offen offset:256 nt
    v_dot2c_f32_bf16 v77, v88, v44
    v_max3_f32 v7, v7, v74, v75
    v_dot2c_f32_bf16 v77, v89, v45
    v_dot2c_f32_bf16 v77, v90, v46
    v_dot2c_f32_bf16 v77, v91, v47
    s_add_u32 s10, s12, 81920
    buffer_load_dwordx4 v[202:205], v4, s[56:59], s10 offen offset:0
    buffer_load_dword v210, v5, s[56:59], s10 offen offset:1024
    buffer_load_dwordx4 v[206:209], v4, s[56:59], s10 offen offset:1280
    buffer_load_dword v211, v5, s[56:59], s10 offen offset:2304
    s_xor_b32 s80, s75, 27
    v_mov_b32 v9, s80
    s_mov_b64 exec, 1
    buffer_store_dword v9, v5, s[76:79], s39 offen
    s_mov_b64 exec, -1
    s_nop 0
    s_add_u32 s10, s9, 2162688
    s_cmp_ge_u32 s10, s8
    s_cselect_b32 s83, 3145728, 0
    s_sub_u32 s10, s10, s83
    s_add_u32 s10, s10, 100663296
    s_waitcnt vmcnt(10)
    s_cmp_lt_u32 s38, 1
    s_cbranch_scc1 Lfb62
    s_waitcnt vmcnt(7)
    s_cmp_lt_u32 s38, 2
    s_cbranch_scc1 Lfb62
    s_waitcnt vmcnt(6)
Lfb62:
    buffer_load_dwordx4 v[108:111], v2, s[44:47], s10 offen offset:0 nt
    v_dot2c_f32_bf16 v77, v92, v48
    v_dot2c_f32_bf16 v77, v93, v49
    v_dot2c_f32_bf16 v77, v94, v50
    v_dot2c_f32_bf16 v77, v95, v51
    s_waitcnt vmcnt(8)
    s_cmp_lt_u32 s38, 1
    s_cbranch_scc1 Lfb63
    s_waitcnt vmcnt(7)
    s_cmp_lt_u32 s38, 2
    s_cbranch_scc1 Lfb63
    s_waitcnt vmcnt(6)
Lfb63:
    buffer_load_dwordx4 v[112:115], v2, s[44:47], s10 offen offset:128 nt
    v_xor_b32 v9, s75, v254
    v_min_u32 v9, 64, v9
    s_and_b32 s80, s7, 31
    s_nop 1
    v_readlane_b32 s81, v9, s80
    s_nop 1
    v_cmp_gt_u32 vcc, s81, v9
    s_nop 1
    s_bcnt1_i32_b32 s82, vcc_lo
    v_cmp_lt_u32 vcc, s81, v9
    s_nop 1
    s_bcnt1_i32_b32 s83, vcc_lo
    s_sub_i32 s82, s82, s83
    v_cmp_eq_u32 vcc, 64, v9
    s_nop 1
    s_bcnt1_i32_b32 s83, vcc_lo
    s_add_i32 s82, s82, s83
    s_cmp_gt_i32 s82, 99
    s_cselect_b32 s38, 2, 1
    s_cmp_lt_i32 s82, -4
    s_cselect_b32 s38, 0, s38
    v_mov_b32 v78, 0
    v_dot2c_f32_bf16 v78, v96, v40
    v_dot2c_f32_bf16 v78, v97, v41
    v_add_f32_dpp v76, v76, v76 quad_perm:[1,0,3,2] row_mask:0xf bank_mask:0xf
    v_dot2c_f32_bf16 v78, v98, v42
    v_add_f32_dpp v77, v77, v77 quad_perm:[1,0,3,2] row_mask:0xf bank_mask:0xf
    v_dot2c_f32_bf16 v78, v99, v43
    v_add_f32_dpp v76, v76, v76 quad_perm:[2,3,0,1] row_mask:0xf bank_mask:0xf
    s_waitcnt vmcnt(8)
    s_cmp_lt_u32 s38, 1
    s_cbranch_scc1 Lfb64
    s_waitcnt vmcnt(7)
    s_cmp_lt_u32 s38, 2
    s_cbranch_scc1 Lfb64
    s_waitcnt vmcnt(1)
Lfb64:
    buffer_load_dwordx4 v[116:119], v2, s[44:47], s10 offen offset:256 nt
    v_dot2c_f32_bf16 v78, v100, v44
    v_add_f32_dpp v77, v77, v77 quad_perm:[2,3,0,1] row_mask:0xf bank_mask:0xf
    v_dot2c_f32_bf16 v78, v101, v45
    v_add_f32_dpp v76, v76, v76 row_half_mirror row_mask:0xf bank_mask:0xf
    v_dot2c_f32_bf16 v78, v102, v46
    v_add_f32_dpp v77, v77, v77 row_half_mirror row_mask:0xf bank_mask:0xf
    v_dot2c_f32_bf16 v78, v103, v47
    v_cvt_pk_bf16_f32 v77, v76, v77
    s_barrier
    s_xor_b32 s80, s75, 28
    v_mov_b32 v9, s80
    s_mov_b64 exec, 1
    buffer_store_dword v9, v5, s[76:79], s39 offen
    s_lshr_b32 s80, s7, 5
    s_lshl_b32 s80, s80, 8
    s_add_u32 s80, s80, 40960
    s_mov_b32 exec_lo, -1
    buffer_load_dword v254, v5, s[76:79], s80 offen sc1
    s_mov_b64 exec, -1
    s_nop 0
    s_add_u32 s10, s9, 2359296
    s_cmp_ge_u32 s10, s8
    s_cselect_b32 s83, 3145728, 0
    s_sub_u32 s10, s10, s83
    s_add_u32 s10, s10, 100663296
    s_waitcnt vmcnt(10)
    s_cmp_lt_u32 s38, 1
    s_cbranch_scc1 Lfb65
    s_waitcnt vmcnt(4)
    s_cmp_lt_u32 s38, 2
    s_cbranch_scc1 Lfb65
    s_waitcnt vmcnt(3)
Lfb65:
    buffer_load_dwordx4 v[84:87], v2, s[44:47], s10 offen offset:0 nt
    v_dot2c_f32_bf16 v78, v104, v48
    v_lshlrev_b32 v76, 16, v77
    v_dot2c_f32_bf16 v78, v105, v49
    v_and_b32 v77, s13, v77
    v_dot2c_f32_bf16 v78, v106, v50
    v_mul_f32 v76, s14, v76
    v_dot2c_f32_bf16 v78, v107, v51
    v_mul_f32 v77, s14, v77
    s_waitcnt vmcnt(5)
    s_cmp_lt_u32 s38, 1
    s_cbranch_scc1 Lfb66
    s_waitcnt vmcnt(4)
    s_cmp_lt_u32 s38, 2
    s_cbranch_scc1 Lfb66
    s_waitcnt vmcnt(3)
Lfb66:
    buffer_load_dwordx4 v[88:91], v2, s[44:47], s10 offen offset:128 nt
    v_mov_b32 v79, 0
    v_dot2c_f32_bf16 v79, v108, v40
    v_dot2c_f32_bf16 v79, v109, v41
    v_cvt_pk_bf16_f32 v77, v76, v77
    v_dot2c_f32_bf16 v79, v110, v42
    v_lshlrev_b32 v76, 16, v77
    v_dot2c_f32_bf16 v79, v111, v43
    v_and_b32 v77, s13, v77
    v_perm_b32 v252, v206, v202, s20
    v_perm_b32 v206, v206, v202, s21
    v_perm_b32 v202, v207, v203, s20
    v_perm_b32 v207, v207, v203, s21
    v_perm_b32 v203, v208, v204, s20
    v_perm_b32 v208, v208, v204, s21
    v_perm_b32 v204, v209, v205, s20
    v_perm_b32 v209, v209, v205, s21
    v_perm_b32 v205, v211, v210, s20
    v_perm_b32 v211, v211, v210, s21
    v_mov_b32 v210, v252
    s_waitcnt vmcnt(5)
    s_cmp_lt_u32 s38, 1
    s_cbranch_scc1 Lfb67
    s_waitcnt vmcnt(4)
    s_cmp_lt_u32 s38, 2
    s_cbranch_scc1 Lfb67
    s_waitcnt vmcnt(1)
Lfb67:
    buffer_load_dwordx4 v[92:95], v2, s[44:47], s10 offen offset:256 nt
    v_dot2c_f32_bf16 v79, v112, v44
    v_max3_f32 v7, v7, v76, v77
    v_dot2c_f32_bf16 v79, v113, v45
    v_dot2c_f32_bf16 v79, v114, v46
    v_dot2c_f32_bf16 v79, v115, v47
    s_add_u32 s10, s12, 84480
    buffer_load_dwordx4 v[192:195], v4, s[56:59], s10 offen offset:0
    buffer_load_dword v200, v5, s[56:59], s10 offen offset:1024
    buffer_load_dwordx4 v[196:199], v4, s[56:59], s10 offen offset:1280
    buffer_load_dword v201, v5, s[56:59], s10 offen offset:2304
    s_xor_b32 s80, s75, 29
    v_mov_b32 v9, s80
    s_mov_b64 exec, 1
    buffer_store_dword v9, v5, s[76:79], s39 offen
    s_mov_b64 exec, -1
    s_nop 0
    s_add_u32 s10, s9, 2555904
    s_cmp_ge_u32 s10, s8
    s_cselect_b32 s83, 3145728, 0
    s_sub_u32 s10, s10, s83
    s_add_u32 s10, s10, 100663296
    s_waitcnt vmcnt(10)
    s_cmp_lt_u32 s38, 1
    s_cbranch_scc1 Lfb68
    s_waitcnt vmcnt(7)
    s_cmp_lt_u32 s38, 2
    s_cbranch_scc1 Lfb68
    s_waitcnt vmcnt(6)
Lfb68:
    buffer_load_dwordx4 v[96:99], v2, s[44:47], s10 offen offset:0 nt
    v_dot2c_f32_bf16 v79, v116, v48
    v_dot2c_f32_bf16 v79, v117, v49
    v_dot2c_f32_bf16 v79, v118, v50
    v_dot2c_f32_bf16 v79, v119, v51
    s_waitcnt vmcnt(8)
    s_cmp_lt_u32 s38, 1
    s_cbranch_scc1 Lfb69
    s_waitcnt vmcnt(7)
    s_cmp_lt_u32 s38, 2
    s_cbranch_scc1 Lfb69
    s_waitcnt vmcnt(6)
Lfb69:
    buffer_load_dwordx4 v[100:103], v2, s[44:47], s10 offen offset:128 nt
    v_xor_b32 v9, s75, v254
    v_min_u32 v9, 64, v9
    s_and_b32 s80, s7, 31
    s_nop 1
    v_readlane_b32 s81, v9, s80
    s_nop 1
    v_cmp_gt_u32 vcc, s81, v9
    s_nop 1
    s_bcnt1_i32_b32 s82, vcc_lo
    v_cmp_lt_u32 vcc, s81, v9
    s_nop 1
    s_bcnt1_i32_b32 s83, vcc_lo
    s_sub_i32 s82, s82, s83
    v_cmp_eq_u32 vcc, 64, v9
    s_nop 1
    s_bcnt1_i32_b32 s83, vcc_lo
    s_add_i32 s82, s82, s83
    s_cmp_gt_i32 s82, 99
    s_cselect_b32 s38, 2, 1
    s_cmp_lt_i32 s82, -4
    s_cselect_b32 s38, 0, s38
    v_mov_b32 v80, 0
    v_dot2c_f32_bf16 v80, v84, v40
    v_dot2c_f32_bf16 v80, v85, v41
    v_add_f32_dpp v78, v78, v78 quad_perm:[1,0,3,2] row_mask:0xf bank_mask:0xf
    v_dot2c_f32_bf16 v80, v86, v42
    v_add_f32_dpp v79, v79, v79 quad_perm:[1,0,3,2] row_mask:0xf bank_mask:0xf
    v_dot2c_f32_bf16 v80, v87, v43
    v_add_f32_dpp v78, v78, v78 quad_perm:[2,3,0,1] row_mask:0xf bank_mask:0xf
    s_waitcnt vmcnt(8)
    s_cmp_lt_u32 s38, 1
    s_cbranch_scc1 Lfb70
    s_waitcnt vmcnt(7)
    s_cmp_lt_u32 s38, 2
    s_cbranch_scc1 Lfb70
    s_waitcnt vmcnt(1)
Lfb70:
    buffer_load_dwordx4 v[104:107], v2, s[44:47], s10 offen offset:256 nt
    v_dot2c_f32_bf16 v80, v88, v44
    v_add_f32_dpp v79, v79, v79 quad_perm:[2,3,0,1] row_mask:0xf bank_mask:0xf
    v_dot2c_f32_bf16 v80, v89, v45
    v_add_f32_dpp v78, v78, v78 row_half_mirror row_mask:0xf bank_mask:0xf
    v_dot2c_f32_bf16 v80, v90, v46
    v_add_f32_dpp v79, v79, v79 row_half_mirror row_mask:0xf bank_mask:0xf
    v_dot2c_f32_bf16 v80, v91, v47
    v_cvt_pk_bf16_f32 v79, v78, v79
    s_barrier
    s_xor_b32 s80, s75, 30
    v_mov_b32 v9, s80
    s_mov_b64 exec, 1
    buffer_store_dword v9, v5, s[76:79], s39 offen
    s_lshr_b32 s80, s7, 5
    s_lshl_b32 s80, s80, 8
    s_add_u32 s80, s80, 40960
    s_mov_b32 exec_lo, -1
    buffer_load_dword v254, v5, s[76:79], s80 offen sc1
    s_mov_b64 exec, -1
    s_nop 0
    s_add_u32 s10, s9, 2752512
    s_cmp_ge_u32 s10, s8
    s_cselect_b32 s83, 3145728, 0
    s_sub_u32 s10, s10, s83
    s_add_u32 s10, s10, 100663296
    s_waitcnt vmcnt(10)
    s_cmp_lt_u32 s38, 1
    s_cbranch_scc1 Lfb71
    s_waitcnt vmcnt(4)
    s_cmp_lt_u32 s38, 2
    s_cbranch_scc1 Lfb71
    s_waitcnt vmcnt(3)
Lfb71:
    buffer_load_dwordx4 v[108:111], v2, s[44:47], s10 offen offset:0 nt
    v_dot2c_f32_bf16 v80, v92, v48
    v_lshlrev_b32 v78, 16, v79
    v_dot2c_f32_bf16 v80, v93, v49
    v_and_b32 v79, s13, v79
    v_dot2c_f32_bf16 v80, v94, v50
    v_mul_f32 v78, s14, v78
    v_dot2c_f32_bf16 v80, v95, v51
    v_mul_f32 v79, s14, v79
    s_waitcnt vmcnt(5)
    s_cmp_lt_u32 s38, 1
    s_cbranch_scc1 Lfb72
    s_waitcnt vmcnt(4)
    s_cmp_lt_u32 s38, 2
    s_cbranch_scc1 Lfb72
    s_waitcnt vmcnt(3)
Lfb72:
    buffer_load_dwordx4 v[112:115], v2, s[44:47], s10 offen offset:128 nt
    v_mov_b32 v81, 0
    v_dot2c_f32_bf16 v81, v96, v40
    v_dot2c_f32_bf16 v81, v97, v41
    v_cvt_pk_bf16_f32 v79, v78, v79
    v_dot2c_f32_bf16 v81, v98, v42
    v_lshlrev_b32 v78, 16, v79
    v_dot2c_f32_bf16 v81, v99, v43
    v_and_b32 v79, s13, v79
    v_perm_b32 v252, v196, v192, s20
    v_perm_b32 v196, v196, v192, s21
    v_perm_b32 v192, v197, v193, s20
    v_perm_b32 v197, v197, v193, s21
    v_perm_b32 v193, v198, v194, s20
    v_perm_b32 v198, v198, v194, s21
    v_perm_b32 v194, v199, v195, s20
    v_perm_b32 v199, v199, v195, s21
    v_perm_b32 v195, v201, v200, s20
    v_perm_b32 v201, v201, v200, s21
    v_mov_b32 v200, v252
    s_waitcnt vmcnt(5)
    s_cmp_lt_u32 s38, 1
    s_cbranch_scc1 Lfb73
    s_waitcnt vmcnt(4)
    s_cmp_lt_u32 s38, 2
    s_cbranch_scc1 Lfb73
    s_waitcnt vmcnt(1)
Lfb73:
    buffer_load_dwordx4 v[116:119], v2, s[44:47], s10 offen offset:256 nt
    v_dot2c_f32_bf16 v81, v100, v44
    v_max3_f32 v7, v7, v78, v79
    v_dot2c_f32_bf16 v81, v101, v45
    v_dot2c_f32_bf16 v81, v102, v46
    v_dot2c_f32_bf16 v81, v103, v47
    s_add_u32 s10, s12, 87040
    buffer_load_dwordx4 v[182:185], v4, s[56:59], s10 offen offset:0
    buffer_load_dword v190, v5, s[56:59], s10 offen offset:1024
    buffer_load_dwordx4 v[186:189], v4, s[56:59], s10 offen offset:1280
    buffer_load_dword v191, v5, s[56:59], s10 offen offset:2304
    s_xor_b32 s80, s75, 31
    v_mov_b32 v9, s80
    s_mov_b64 exec, 1
    buffer_store_dword v9, v5, s[76:79], s39 offen
    s_mov_b64 exec, -1
    s_nop 0
    s_add_u32 s10, s9, 2949120
    s_cmp_ge_u32 s10, s8
    s_cselect_b32 s83, 3145728, 0
    s_sub_u32 s10, s10, s83
    s_add_u32 s10, s10, 100663296
    s_waitcnt vmcnt(10)
    s_cmp_lt_u32 s38, 1
    s_cbranch_scc1 Lfb74
    s_waitcnt vmcnt(7)
    s_cmp_lt_u32 s38, 2
    s_cbranch_scc1 Lfb74
    s_waitcnt vmcnt(6)
Lfb74:
    buffer_load_dwordx4 v[84:87], v2, s[44:47], s10 offen offset:0 nt
    v_dot2c_f32_bf16 v81, v104, v48
    v_dot2c_f32_bf16 v81, v105, v49
    v_dot2c_f32_bf16 v81, v106, v50
    v_dot2c_f32_bf16 v81, v107, v51
    s_waitcnt vmcnt(8)
    s_cmp_lt_u32 s38, 1
    s_cbranch_scc1 Lfb75
    s_waitcnt vmcnt(7)
    s_cmp_lt_u32 s38, 2
    s_cbranch_scc1 Lfb75
    s_waitcnt vmcnt(6)
Lfb75:
    buffer_load_dwordx4 v[88:91], v2, s[44:47], s10 offen offset:128 nt
    v_xor_b32 v9, s75, v254
    v_min_u32 v9, 64, v9
    s_and_b32 s80, s7, 31
    s_nop 1
    v_readlane_b32 s81, v9, s80
    s_nop 1
    v_cmp_gt_u32 vcc, s81, v9
    s_nop 1
    s_bcnt1_i32_b32 s82, vcc_lo
    v_cmp_lt_u32 vcc, s81, v9
    s_nop 1
    s_bcnt1_i32_b32 s83, vcc_lo
    s_sub_i32 s82, s82, s83
    v_cmp_eq_u32 vcc, 64, v9
    s_nop 1
    s_bcnt1_i32_b32 s83, vcc_lo
    s_add_i32 s82, s82, s83
    s_cmp_gt_i32 s82, 99
    s_cselect_b32 s38, 2, 1
    s_cmp_lt_i32 s82, -4
    s_cselect_b32 s38, 0, s38
    v_mov_b32 v82, 0
    v_dot2c_f32_bf16 v82, v108, v40
    v_dot2c_f32_bf16 v82, v109, v41
    v_add_f32_dpp v80, v80, v80 quad_perm:[1,0,3,2] row_mask:0xf bank_mask:0xf
    v_dot2c_f32_bf16 v82, v110, v42
    v_add_f32_dpp v81, v81, v81 quad_perm:[1,0,3,2] row_mask:0xf bank_mask:0xf
    v_dot2c_f32_bf16 v82, v111, v43
    v_add_f32_dpp v80, v80, v80 quad_perm:[2,3,0,1] row_mask:0xf bank_mask:0xf
    s_waitcnt vmcnt(8)
    s_cmp_lt_u32 s38, 1
    s_cbranch_scc1 Lfb76
    s_waitcnt vmcnt(7)
    s_cmp_lt_u32 s38, 2
    s_cbranch_scc1 Lfb76
    s_waitcnt vmcnt(1)
Lfb76:
    buffer_load_dwordx4 v[92:95], v2, s[44:47], s10 offen offset:256 nt
    v_dot2c_f32_bf16 v82, v112, v44
    v_add_f32_dpp v81, v81, v81 quad_perm:[2,3,0,1] row_mask:0xf bank_mask:0xf
    v_dot2c_f32_bf16 v82, v113, v45
    v_add_f32_dpp v80, v80, v80 row_half_mirror row_mask:0xf bank_mask:0xf
    v_dot2c_f32_bf16 v82, v114, v46
    v_add_f32_dpp v81, v81, v81 row_half_mirror row_mask:0xf bank_mask:0xf
    v_dot2c_f32_bf16 v82, v115, v47
    v_cvt_pk_bf16_f32 v81, v80, v81
    s_barrier
    s_xor_b32 s80, s75, 32
    v_mov_b32 v9, s80
    s_mov_b64 exec, 1
    buffer_store_dword v9, v5, s[76:79], s39 offen
    s_lshr_b32 s80, s7, 5
    s_lshl_b32 s80, s80, 8
    s_add_u32 s80, s80, 40960
    s_mov_b32 exec_lo, -1
    buffer_load_dword v254, v5, s[76:79], s80 offen sc1
    s_mov_b64 exec, -1
    s_nop 0
    s_add_u32 s10, s9, 0
    s_cmp_ge_u32 s10, s8
    s_cselect_b32 s83, 3145728, 0
    s_sub_u32 s10, s10, s83
    s_waitcnt vmcnt(10)
    s_cmp_lt_u32 s38, 1
    s_cbranch_scc1 Lfb77
    s_waitcnt vmcnt(4)
    s_cmp_lt_u32 s38, 2
    s_cbranch_scc1 Lfb77
    s_waitcnt vmcnt(3)
Lfb77:
    buffer_load_dwordx4 v[96:99], v2, s[48:51], s10 offen offset:0 nt
    v_dot2c_f32_bf16 v82, v116, v48
    v_lshlrev_b32 v80, 16, v81
    v_dot2c_f32_bf16 v82, v117, v49
    v_and_b32 v81, s13, v81
    v_dot2c_f32_bf16 v82, v118, v50
    v_mul_f32 v80, s14, v80
    v_dot2c_f32_bf16 v82, v119, v51
    v_mul_f32 v81, s14, v81
    s_waitcnt vmcnt(5)
    s_cmp_lt_u32 s38, 1
    s_cbranch_scc1 Lfb78
    s_waitcnt vmcnt(4)
    s_cmp_lt_u32 s38, 2
    s_cbranch_scc1 Lfb78
    s_waitcnt vmcnt(3)
Lfb78:
    buffer_load_dwordx4 v[100:103], v2, s[48:51], s10 offen offset:128 nt
    v_mov_b32 v83, 0
    v_dot2c_f32_bf16 v83, v84, v40
    v_dot2c_f32_bf16 v83, v85, v41
    v_cvt_pk_bf16_f32 v81, v80, v81
    v_dot2c_f32_bf16 v83, v86, v42
    v_lshlrev_b32 v80, 16, v81
    v_dot2c_f32_bf16 v83, v87, v43
    v_and_b32 v81, s13, v81
    v_perm_b32 v252, v186, v182, s20
    v_perm_b32 v186, v186, v182, s21
    v_perm_b32 v182, v187, v183, s20
    v_perm_b32 v187, v187, v183, s21
    v_perm_b32 v183, v188, v184, s20
    v_perm_b32 v188, v188, v184, s21
    v_perm_b32 v184, v189, v185, s20
    v_perm_b32 v189, v189, v185, s21
    v_perm_b32 v185, v191, v190, s20
    v_perm_b32 v191, v191, v190, s21
    v_mov_b32 v190, v252
    s_waitcnt vmcnt(5)
    s_cmp_lt_u32 s38, 1
    s_cbranch_scc1 Lfb79
    s_waitcnt vmcnt(4)
    s_cmp_lt_u32 s38, 2
    s_cbranch_scc1 Lfb79
    s_waitcnt vmcnt(1)
Lfb79:
    buffer_load_dwordx4 v[104:107], v2, s[48:51], s10 offen offset:256 nt
    v_dot2c_f32_bf16 v83, v88, v44
    v_max3_f32 v7, v7, v80, v81
    v_dot2c_f32_bf16 v83, v89, v45
    v_dot2c_f32_bf16 v83, v90, v46
    v_dot2c_f32_bf16 v83, v91, v47
    s_add_u32 s10, s12, 89600
    buffer_load_dwordx4 v[172:175], v4, s[56:59], s10 offen offset:0
    buffer_load_dword v180, v5, s[56:59], s10 offen offset:1024
    buffer_load_dwordx4 v[176:179], v4, s[56:59], s10 offen offset:1280
    buffer_load_dword v181, v5, s[56:59], s10 offen offset:2304
    s_xor_b32 s80, s75, 33
    v_mov_b32 v9, s80
    s_mov_b64 exec, 1
    buffer_store_dword v9, v5, s[76:79], s39 offen
    s_mov_b64 exec, -1
    s_nop 0
    s_add_u32 s10, s9, 196608
    s_cmp_ge_u32 s10, s8
    s_cselect_b32 s83, 3145728, 0
    s_sub_u32 s10, s10, s83
    s_waitcnt vmcnt(10)
    s_cmp_lt_u32 s38, 1
    s_cbranch_scc1 Lfb80
    s_waitcnt vmcnt(7)
    s_cmp_lt_u32 s38, 2
    s_cbranch_scc1 Lfb80
    s_waitcnt vmcnt(6)
Lfb80:
    buffer_load_dwordx4 v[108:111], v2, s[48:51], s10 offen offset:0 nt
    v_dot2c_f32_bf16 v83, v92, v48
    v_dot2c_f32_bf16 v83, v93, v49
    v_dot2c_f32_bf16 v83, v94, v50
    v_dot2c_f32_bf16 v83, v95, v51
    v_add_f32_dpp v82, v82, v82 quad_perm:[1,0,3,2] row_mask:0xf bank_mask:0xf
    s_nop 1
    v_add_f32_dpp v83, v83, v83 quad_perm:[1,0,3,2] row_mask:0xf bank_mask:0xf
    v_add_f32_dpp v82, v82, v82 quad_perm:[2,3,0,1] row_mask:0xf bank_mask:0xf
    s_nop 0
    v_add_f32_dpp v83, v83, v83 quad_perm:[2,3,0,1] row_mask:0xf bank_mask:0xf
    v_add_f32_dpp v82, v82, v82 row_half_mirror row_mask:0xf bank_mask:0xf
    s_nop 0
    v_add_f32_dpp v83, v83, v83 row_half_mirror row_mask:0xf bank_mask:0xf
    v_cvt_pk_bf16_f32 v83, v82, v83
    v_lshlrev_b32 v82, 16, v83
    v_and_b32 v83, s13, v83
    v_mul_f32 v82, s14, v82
    v_mul_f32 v83, s14, v83
    v_cvt_pk_bf16_f32 v83, v82, v83
    v_lshlrev_b32 v82, 16, v83
    v_and_b32 v83, s13, v83
    v_max3_f32 v7, v7, v82, v83
    s_nop 1
    v_max_f32_dpp v7, v7, v7 row_ror:8 row_mask:0xf bank_mask:0xf
    v_mov_b32 v14, v7
    s_nop 1
    v_permlane16_swap_b32 v7, v14
    v_max_f32 v7, v7, v14
    v_mov_b32 v14, v7
    s_waitcnt vmcnt(8)
    s_cmp_lt_u32 s38, 1
    s_cbranch_scc1 Lfb81
    s_waitcnt vmcnt(7)
    s_cmp_lt_u32 s38, 2
    s_cbranch_scc1 Lfb81
    s_waitcnt vmcnt(6)
Lfb81:
    buffer_load_dwordx4 v[112:115], v2, s[48:51], s10 offen offset:128 nt
    v_xor_b32 v9, s75, v254
    v_min_u32 v9, 64, v9
    s_and_b32 s80, s7, 31
    s_nop 1
    v_readlane_b32 s81, v9, s80
    s_nop 1
    v_cmp_gt_u32 vcc, s81, v9
    s_nop 1
    s_bcnt1_i32_b32 s82, vcc_lo
    v_cmp_lt_u32 vcc, s81, v9
    s_nop 1
    s_bcnt1_i32_b32 s83, vcc_lo
    s_sub_i32 s82, s82, s83
    v_cmp_eq_u32 vcc, 64, v9
    s_nop 1
    s_bcnt1_i32_b32 s83, vcc_lo
    s_add_i32 s82, s82, s83
    s_cmp_gt_i32 s82, 99
    s_cselect_b32 s38, 2, 1
    s_cmp_lt_i32 s82, -4
    s_cselect_b32 s38, 0, s38
    v_lshlrev_b32 v253, 16, v52
    v_dot2c_f32_bf16 v16, v96, v52
    v_dot2c_f32_bf16 v17, v96, v253
    v_dot2c_f32_bf16 v18, v97, v52
    v_dot2c_f32_bf16 v19, v97, v253
    v_dot2c_f32_bf16 v20, v98, v52
    v_dot2c_f32_bf16 v21, v98, v253
    v_dot2c_f32_bf16 v22, v99, v52
    v_dot2c_f32_bf16 v23, v99, v253
    v_permlane32_swap_b32 v7, v14
    v_max_f32 v7, v7, v14
    v_mul_f32 v3, s15, v7
    v_fma_f32 v68, v68, s15, -v3
    v_fma_f32 v69, v69, s15, -v3
    v_fma_f32 v70, v70, s15, -v3
    v_fma_f32 v71, v71, s15, -v3
    v_exp_f32 v68, v68
    v_exp_f32 v69, v69
    v_exp_f32 v70, v70
    v_exp_f32 v71, v71
    v_mov_b32 v8, v68
    v_add_f32 v8, v8, v69
    v_add_f32 v8, v8, v70
    v_add_f32 v8, v8, v71
    v_cvt_pk_bf16_f32 v68, v68, 0
    v_cvt_pk_bf16_f32 v69, v69, 0
    v_cvt_pk_bf16_f32 v70, v70, 0
    v_cvt_pk_bf16_f32 v71, v71, 0
    v_fma_f32 v72, v72, s15, -v3
    s_waitcnt vmcnt(8)
    s_cmp_lt_u32 s38, 1
    s_cbranch_scc1 Lfb82
    s_waitcnt vmcnt(7)
    s_cmp_lt_u32 s38, 2
    s_cbranch_scc1 Lfb82
    s_waitcnt vmcnt(1)
Lfb82:
    buffer_load_dwordx4 v[116:119], v2, s[48:51], s10 offen offset:256 nt
    v_dot2c_f32_bf16 v24, v100, v52
    v_dot2c_f32_bf16 v25, v100, v253
    v_dot2c_f32_bf16 v26, v101, v52
    v_dot2c_f32_bf16 v27, v101, v253
    v_dot2c_f32_bf16 v28, v102, v52
    v_dot2c_f32_bf16 v29, v102, v253
    v_dot2c_f32_bf16 v30, v103, v52
    v_dot2c_f32_bf16 v31, v103, v253
    v_fma_f32 v73, v73, s15, -v3
    v_fma_f32 v74, v74, s15, -v3
    v_fma_f32 v75, v75, s15, -v3
    v_exp_f32 v72, v72
    v_exp_f32 v73, v73
    v_exp_f32 v74, v74
    v_exp_f32 v75, v75
    v_add_f32 v8, v8, v72
    v_add_f32 v8, v8, v73
    v_add_f32 v8, v8, v74
    v_add_f32 v8, v8, v75
    v_cvt_pk_bf16_f32 v72, v72, 0
    v_cvt_pk_bf16_f32 v73, v73, 0
    v_cvt_pk_bf16_f32 v74, v74, 0
    v_cvt_pk_bf16_f32 v75, v75, 0
    v_fma_f32 v76, v76, s15, -v3
    v_fma_f32 v77, v77, s15, -v3
    v_fma_f32 v78, v78, s15, -v3
    v_fma_f32 v79, v79, s15, -v3
    v_exp_f32 v76, v76
    v_exp_f32 v77, v77
    v_exp_f32 v78, v78
    v_exp_f32 v79, v79
    v_add_f32 v8, v8, v76
    v_add_f32 v8, v8, v77
    v_add_f32 v8, v8, v78
    v_add_f32 v8, v8, v79
    v_cvt_pk_bf16_f32 v76, v76, 0
    v_cvt_pk_bf16_f32 v77, v77, 0
    v_cvt_pk_bf16_f32 v78, v78, 0
    v_cvt_pk_bf16_f32 v79, v79, 0
    v_fma_f32 v80, v80, s15, -v3
    v_fma_f32 v81, v81, s15, -v3
    v_fma_f32 v82, v82, s15, -v3
    v_fma_f32 v83, v83, s15, -v3
    v_exp_f32 v80, v80
    v_exp_f32 v81, v81
    v_exp_f32 v82, v82
    v_exp_f32 v83, v83
    v_add_f32 v8, v8, v80
    s_barrier
    s_xor_b32 s80, s75, 34
    v_mov_b32 v9, s80
    s_mov_b64 exec, 1
    buffer_store_dword v9, v5, s[76:79], s39 offen
    s_lshr_b32 s80, s7, 5
    s_lshl_b32 s80, s80, 8
    s_add_u32 s80, s80, 40960
    s_mov_b32 exec_lo, -1
    buffer_load_dword v254, v5, s[76:79], s80 offen sc1
    s_mov_b64 exec, -1
    s_nop 0
    s_add_u32 s10, s9, 393216
    s_cmp_ge_u32 s10, s8
    s_cselect_b32 s83, 3145728, 0
    s_sub_u32 s10, s10, s83
    s_waitcnt vmcnt(10)
    s_cmp_lt_u32 s38, 1
    s_cbranch_scc1 Lfb83
    s_waitcnt vmcnt(4)
    s_cmp_lt_u32 s38, 2
    s_cbranch_scc1 Lfb83
    s_waitcnt vmcnt(3)
Lfb83:
    buffer_load_dwordx4 v[84:87], v2, s[48:51], s10 offen offset:0 nt
    v_dot2c_f32_bf16 v32, v104, v52
    v_dot2c_f32_bf16 v33, v104, v253
    v_dot2c_f32_bf16 v34, v105, v52
    v_dot2c_f32_bf16 v35, v105, v253
    v_dot2c_f32_bf16 v36, v106, v52
    v_dot2c_f32_bf16 v37, v106, v253
    v_dot2c_f32_bf16 v38, v107, v52
    v_dot2c_f32_bf16 v39, v107, v253
    v_add_f32 v8, v8, v81
    v_add_f32 v8, v8, v82
    v_add_f32 v8, v8, v83
    v_cvt_pk_bf16_f32 v80, v80, 0
    v_cvt_pk_bf16_f32 v81, v81, 0
    v_cvt_pk_bf16_f32 v82, v82, 0
    v_cvt_pk_bf16_f32 v83, v83, 0
    v_add_f32_dpp v8, v8, v8 row_ror:8 row_mask:0xf bank_mask:0xf
    v_mov_b32 v14, v8
    s_nop 1
    v_permlane16_swap_b32 v8, v14
    v_add_f32 v8, v8, v14
    v_mov_b32 v14, v8
    s_nop 1
    v_permlane32_swap_b32 v8, v14
    v_add_f32 v8, v8, v14
    v_lshlrev_b32_e64 v14, 3, s3
    ds_write_b32 v14, v7 offset:9024
    ds_write_b32 v14, v8 offset:9028
    v_mov_b32 v7, 0xff800000
    s_waitcnt vmcnt(5)
    s_cmp_lt_u32 s38, 1
    s_cbranch_scc1 Lfb84
    s_waitcnt vmcnt(4)
    s_cmp_lt_u32 s38, 2
    s_cbranch_scc1 Lfb84
    s_waitcnt vmcnt(3)
Lfb84:
    buffer_load_dwordx4 v[88:91], v2, s[48:51], s10 offen offset:128 nt
    v_perm_b32 v252, v176, v172, s20
    v_perm_b32 v176, v176, v172, s21
    v_perm_b32 v172, v177, v173, s20
    v_perm_b32 v177, v177, v173, s21
    v_perm_b32 v173, v178, v174, s20
    v_perm_b32 v178, v178, v174, s21
    v_perm_b32 v174, v179, v175, s20
    v_perm_b32 v179, v179, v175, s21
    v_perm_b32 v175, v181, v180, s20
    v_perm_b32 v181, v181, v180, s21
    v_mov_b32 v180, v252
    v_lshlrev_b32 v253, 16, v53
    v_dot2c_f32_bf16 v16, v108, v53
    v_dot2c_f32_bf16 v17, v108, v253
    v_dot2c_f32_bf16 v18, v109, v53
    v_dot2c_f32_bf16 v19, v109, v253
    v_dot2c_f32_bf16 v20, v110, v53
    v_dot2c_f32_bf16 v21, v110, v253
    v_dot2c_f32_bf16 v22, v111, v53
    v_dot2c_f32_bf16 v23, v111, v253
    s_waitcnt vmcnt(5)
    s_cmp_lt_u32 s38, 1
    s_cbranch_scc1 Lfb85
    s_waitcnt vmcnt(4)
    s_cmp_lt_u32 s38, 2
    s_cbranch_scc1 Lfb85
    s_waitcnt vmcnt(1)
Lfb85:
    buffer_load_dwordx4 v[92:95], v2, s[48:51], s10 offen offset:256 nt
    v_dot2c_f32_bf16 v24, v112, v53
    v_dot2c_f32_bf16 v25, v112, v253
    v_dot2c_f32_bf16 v26, v113, v53
    v_dot2c_f32_bf16 v27, v113, v253
    v_dot2c_f32_bf16 v28, v114, v53
    v_dot2c_f32_bf16 v29, v114, v253
    v_dot2c_f32_bf16 v30, v115, v53
    v_dot2c_f32_bf16 v31, v115, v253
    s_waitcnt lgkmcnt(0)
    s_barrier
    s_add_u32 s10, s12, 163840
    buffer_load_dwordx4 v[162:165], v4, s[56:59], s10 offen offset:0
    buffer_load_dword v170, v5, s[56:59], s10 offen offset:1024
    buffer_load_dwordx4 v[166:169], v4, s[56:59], s10 offen offset:1280
    buffer_load_dword v171, v5, s[56:59], s10 offen offset:2304
    v_and_b32 v9, 31, v1
    v_lshlrev_b32 v9, 3, v9
    ds_read_b64 v[12:13], v9 offset:8960
    s_getreg_b32 s33, hwreg(HW_REG_XCC_ID, 0, 4)
    s_xor_b32 s33, s33, s75
    s_lshl_b32 s81, s7, 7
    s_add_u32 s81, s81, 4096
    s_cmp_eq_u32 s3, 0
    s_cselect_b32 s80, s81, 1073741824
    v_lshrrev_b32 v9, 2, v9
    s_add_u32 s28, s3, 0
    s_add_u32 s29, s3, 8
    s_waitcnt lgkmcnt(0)
    v_mov_b32 v10, v12
    s_nop 1
    v_max_f32_dpp v10, v10, v10 quad_perm:[1,0,3,2] row_mask:0xf bank_mask:0xf
    s_nop 1
    v_max_f32_dpp v10, v10, v10 quad_perm:[2,3,0,1] row_mask:0xf bank_mask:0xf
    s_nop 1
    v_max_f32_dpp v10, v10, v10 row_half_mirror row_mask:0xf bank_mask:0xf
    v_sub_f32 v12, v12, v10
    v_mul_f32 v12, s15, v12
    v_exp_f32 v11, v12
    s_nop 0
    v_mul_f32 v12, v11, v13
    v_readlane_b32 s28, v11, s28
    v_readlane_b32 s29, v11, s29
    v_add_f32_dpp v12, v12, v12 quad_perm:[1,0,3,2] row_mask:0xf bank_mask:0xf
    s_nop 1
    v_add_f32_dpp v12, v12, v12 quad_perm:[2,3,0,1] row_mask:0xf bank_mask:0xf
    s_nop 1
    v_add_f32_dpp v12, v12, v12 row_half_mirror row_mask:0xf bank_mask:0xf
    v_mov_b32 v11, s75
    v_mov_b32 v13, s33
    s_mov_b64 exec, 257
    buffer_store_dwordx4 v[10:13], v9, s[76:79], s80 offen
    s_mov_b64 exec, -1
    s_nop 0
    s_xor_b32 s80, s75, 35
    v_mov_b32 v9, s80
    s_mov_b64 exec, 1
    buffer_store_dword v9, v5, s[76:79], s39 offen
    s_mov_b64 exec, -1
    s_nop 0
    s_add_u32 s10, s9, 589824
    s_cmp_ge_u32 s10, s8
    s_cselect_b32 s83, 3145728, 0
    s_sub_u32 s10, s10, s83
    s_waitcnt vmcnt(11)
    s_cmp_lt_u32 s38, 1
    s_cbranch_scc1 Lfb86
    s_waitcnt vmcnt(8)
    s_cmp_lt_u32 s38, 2
    s_cbranch_scc1 Lfb86
    s_waitcnt vmcnt(7)
Lfb86:
    buffer_load_dwordx4 v[96:99], v2, s[48:51], s10 offen offset:0 nt
    v_dot2c_f32_bf16 v32, v116, v53
    v_dot2c_f32_bf16 v33, v116, v253
    v_dot2c_f32_bf16 v34, v117, v53
    v_dot2c_f32_bf16 v35, v117, v253
    v_dot2c_f32_bf16 v36, v118, v53
    v_dot2c_f32_bf16 v37, v118, v253
    v_dot2c_f32_bf16 v38, v119, v53
    v_dot2c_f32_bf16 v39, v119, v253
    v_and_b32 v10, 7, v1
    v_mul_u32_u24 v11, 800, v10
    v_lshlrev_b32 v10, 5, v10
    v_bfe_u32 v9, v1, 5, 1
    v_lshl_add_u32 v10, v9, 4, v10
    v_bfe_u32 v9, v1, 3, 2
    v_lshl_add_u32 v10, v9, 2, v10
    s_mul_i32 s80, s3, 800
    v_add_u32 v10, s80, v10
    v_lshrrev_b32 v9, 3, v1
    v_lshl_add_u32 v11, v9, 2, v11
    s_lshl_b32 s80, s3, 5
    v_add_u32 v11, s80, v11
    v_and_b32 v12, 15, v1
    v_lshlrev_b32 v8, 5, v12
    v_lshlrev_b32 v3, 1, v12
    s_mul_i32 s80, s3, 5120
    v_lshl_add_u32 v12, v1, 5, s80
    v_lshl_add_u32 v6, v1, 3, s80
    s_mul_i32 s80, s3, 320
    v_lshl_add_u32 v13, v1, 4, s80
    s_mul_i32 s11, s7, 5120
    s_add_u32 s11, s11, 327680
    s_mul_i32 s22, s42, 2560
    s_add_u32 s22, s22, s43
    s_add_u32 s22, s22, 327680
    s_add_u32 s5, s22, 655360
    s_cmp_eq_u32 s42, 1
    s_cselect_b32 s5, s5, 1073741824
    s_cselect_b64 s[30:31], -1, 0
    s_cselect_b32 s80, 0, s3
    s_cmp_lt_u32 s80, 2
    s_cselect_b32 s22, s22, 1073741824
    s_cselect_b64 s[24:25], -1, 0
    s_mul_i32 s23, s42, 1280
    s_lshr_b32 s80, s43, 1
    s_add_u32 s23, s23, s80
    s_waitcnt vmcnt(9)
    s_cmp_lt_u32 s38, 1
    s_cbranch_scc1 Lfb87
    s_waitcnt vmcnt(8)
    s_cmp_lt_u32 s38, 2
    s_cbranch_scc1 Lfb87
    s_waitcnt vmcnt(7)
Lfb87:
    buffer_load_dwordx4 v[100:103], v2, s[48:51], s10 offen offset:128 nt
    v_xor_b32 v9, s75, v254
    v_min_u32 v9, 64, v9
    s_and_b32 s80, s7, 31
    s_nop 1
    v_readlane_b32 s81, v9, s80
    s_nop 1
    v_cmp_gt_u32 vcc, s81, v9
    s_nop 1
    s_bcnt1_i32_b32 s82, vcc_lo
    v_cmp_lt_u32 vcc, s81, v9
    s_nop 1
    s_bcnt1_i32_b32 s83, vcc_lo
    s_sub_i32 s82, s82, s83
    v_cmp_eq_u32 vcc, 64, v9
    s_nop 1
    s_bcnt1_i32_b32 s83, vcc_lo
    s_add_i32 s82, s82, s83
    s_cmp_gt_i32 s82, 99
    s_cselect_b32 s38, 2, 1
    s_cmp_lt_i32 s82, -4
    s_cselect_b32 s38, 0, s38
    v_lshlrev_b32 v253, 16, v54
    v_dot2c_f32_bf16 v16, v84, v54
    v_dot2c_f32_bf16 v17, v84, v253
    v_dot2c_f32_bf16 v18, v85, v54
    v_dot2c_f32_bf16 v19, v85, v253
    v_dot2c_f32_bf16 v20, v86, v54
    v_dot2c_f32_bf16 v21, v86, v253
    v_dot2c_f32_bf16 v22, v87, v54
    v_dot2c_f32_bf16 v23, v87, v253
    s_waitcnt vmcnt(9)
    s_cmp_lt_u32 s38, 1
    s_cbranch_scc1 Lfb88
    s_waitcnt vmcnt(8)
    s_cmp_lt_u32 s38, 2
    s_cbranch_scc1 Lfb88
    s_waitcnt vmcnt(1)
Lfb88:
    buffer_load_dwordx4 v[104:107], v2, s[48:51], s10 offen offset:256 nt
    v_dot2c_f32_bf16 v24, v88, v54
    v_dot2c_f32_bf16 v25, v88, v253
    v_dot2c_f32_bf16 v26, v89, v54
    v_dot2c_f32_bf16 v27, v89, v253
    v_dot2c_f32_bf16 v28, v90, v54
    v_dot2c_f32_bf16 v29, v90, v253
    v_dot2c_f32_bf16 v30, v91, v54
    v_dot2c_f32_bf16 v31, v91, v253
    s_barrier
    s_xor_b32 s80, s75, 36
    v_mov_b32 v9, s80
    s_mov_b64 exec, 1
    buffer_store_dword v9, v5, s[76:79], s39 offen
    s_lshr_b32 s80, s7, 5
    s_lshl_b32 s80, s80, 8
    s_add_u32 s80, s80, 40960
    s_mov_b32 exec_lo, -1
    buffer_load_dword v254, v5, s[76:79], s80 offen sc1
    s_mov_b64 exec, -1
    s_nop 0
    s_add_u32 s10, s9, 786432
    s_cmp_ge_u32 s10, s8
    s_cselect_b32 s83, 3145728, 0
    s_sub_u32 s10, s10, s83
    s_waitcnt vmcnt(11)
    s_cmp_lt_u32 s38, 1
    s_cbranch_scc1 Lfb89
    s_waitcnt vmcnt(4)
    s_cmp_lt_u32 s38, 2
    s_cbranch_scc1 Lfb89
    s_waitcnt vmcnt(3)
Lfb89:
    buffer_load_dwordx4 v[108:111], v2, s[48:51], s10 offen offset:0 nt
    v_dot2c_f32_bf16 v32, v92, v54
    v_dot2c_f32_bf16 v33, v92, v253
    v_dot2c_f32_bf16 v34, v93, v54
    v_dot2c_f32_bf16 v35, v93, v253
    v_dot2c_f32_bf16 v36, v94, v54
    v_dot2c_f32_bf16 v37, v94, v253
    v_dot2c_f32_bf16 v38, v95, v54
    v_dot2c_f32_bf16 v39, v95, v253
    s_waitcnt vmcnt(5)
    s_cmp_lt_u32 s38, 1
    s_cbranch_scc1 Lfb90
    s_waitcnt vmcnt(4)
    s_cmp_lt_u32 s38, 2
    s_cbranch_scc1 Lfb90
    s_waitcnt vmcnt(3)
Lfb90:
    buffer_load_dwordx4 v[112:115], v2, s[48:51], s10 offen offset:128 nt
    v_perm_b32 v252, v166, v162, s20
    v_perm_b32 v166, v166, v162, s21
    v_perm_b32 v162, v167, v163, s20
    v_perm_b32 v167, v167, v163, s21
    v_perm_b32 v163, v168, v164, s20
    v_perm_b32 v168, v168, v164, s21
    v_perm_b32 v164, v169, v165, s20
    v_perm_b32 v169, v169, v165, s21
    v_perm_b32 v165, v171, v170, s20
    v_perm_b32 v171, v171, v170, s21
    v_mov_b32 v170, v252
    v_lshlrev_b32 v253, 16, v55
    v_dot2c_f32_bf16 v16, v96, v55
    v_dot2c_f32_bf16 v17, v96, v253
    v_dot2c_f32_bf16 v18, v97, v55
    v_dot2c_f32_bf16 v19, v97, v253
    v_dot2c_f32_bf16 v20, v98, v55
    v_dot2c_f32_bf16 v21, v98, v253
    v_dot2c_f32_bf16 v22, v99, v55
    v_dot2c_f32_bf16 v23, v99, v253
    s_waitcnt vmcnt(5)
    s_cmp_lt_u32 s38, 1
    s_cbranch_scc1 Lfb91
    s_waitcnt vmcnt(4)
    s_cmp_lt_u32 s38, 2
    s_cbranch_scc1 Lfb91
    s_waitcnt vmcnt(1)
Lfb91:
    buffer_load_dwordx4 v[116:119], v2, s[48:51], s10 offen offset:256 nt
    v_dot2c_f32_bf16 v24, v100, v55
    v_dot2c_f32_bf16 v25, v100, v253
    v_dot2c_f32_bf16 v26, v101, v55
    v_dot2c_f32_bf16 v27, v101, v253
    v_dot2c_f32_bf16 v28, v102, v55
    v_dot2c_f32_bf16 v29, v102, v253
    v_dot2c_f32_bf16 v30, v103, v55
    v_dot2c_f32_bf16 v31, v103, v253
    s_add_u32 s10, s12, 166400
    buffer_load_dwordx4 v[152:155], v4, s[56:59], s10 offen offset:0
    buffer_load_dword v160, v5, s[56:59], s10 offen offset:1024
    buffer_load_dwordx4 v[156:159], v4, s[56:59], s10 offen offset:1280
    buffer_load_dword v161, v5, s[56:59], s10 offen offset:2304
    s_xor_b32 s80, s75, 37
    v_mov_b32 v9, s80
    s_mov_b64 exec, 1
    buffer_store_dword v9, v5, s[76:79], s39 offen
    s_mov_b64 exec, -1
    s_nop 0
    s_add_u32 s10, s9, 983040
    s_cmp_ge_u32 s10, s8
    s_cselect_b32 s83, 3145728, 0
    s_sub_u32 s10, s10, s83
    s_waitcnt vmcnt(10)
    s_cmp_lt_u32 s38, 1
    s_cbranch_scc1 Lfb92
    s_waitcnt vmcnt(7)
    s_cmp_lt_u32 s38, 2
    s_cbranch_scc1 Lfb92
    s_waitcnt vmcnt(6)
Lfb92:
    buffer_load_dwordx4 v[84:87], v2, s[48:51], s10 offen offset:0 nt
    v_dot2c_f32_bf16 v32, v104, v55
    v_dot2c_f32_bf16 v33, v104, v253
    v_dot2c_f32_bf16 v34, v105, v55
    v_dot2c_f32_bf16 v35, v105, v253
    v_dot2c_f32_bf16 v36, v106, v55
    v_dot2c_f32_bf16 v37, v106, v253
    v_dot2c_f32_bf16 v38, v107, v55
    v_dot2c_f32_bf16 v39, v107, v253
    s_waitcnt vmcnt(8)
    s_cmp_lt_u32 s38, 1
    s_cbranch_scc1 Lfb93
    s_waitcnt vmcnt(7)
    s_cmp_lt_u32 s38, 2
    s_cbranch_scc1 Lfb93
    s_waitcnt vmcnt(6)
Lfb93:
    buffer_load_dwordx4 v[88:91], v2, s[48:51], s10 offen offset:128 nt
    v_xor_b32 v9, s75, v254
    v_min_u32 v9, 64, v9
    s_and_b32 s80, s7, 31
    s_nop 1
    v_readlane_b32 s81, v9, s80
    s_nop 1
    v_cmp_gt_u32 vcc, s81, v9
    s_nop 1
    s_bcnt1_i32_b32 s82, vcc_lo
    v_cmp_lt_u32 vcc, s81, v9
    s_nop 1
    s_bcnt1_i32_b32 s83, vcc_lo
    s_sub_i32 s82, s82, s83
    v_cmp_eq_u32 vcc, 64, v9
    s_nop 1
    s_bcnt1_i32_b32 s83, vcc_lo
    s_add_i32 s82, s82, s83
    s_cmp_gt_i32 s82, 99
    s_cselect_b32 s38, 2, 1
    s_cmp_lt_i32 s82, -4
    s_cselect_b32 s38, 0, s38
    v_lshlrev_b32 v253, 16, v56
    v_dot2c_f32_bf16 v16, v108, v56
    v_dot2c_f32_bf16 v17, v108, v253
    v_dot2c_f32_bf16 v18, v109, v56
    v_dot2c_f32_bf16 v19, v109, v253
    v_dot2c_f32_bf16 v20, v110, v56
    v_dot2c_f32_bf16 v21, v110, v253
    v_dot2c_f32_bf16 v22, v111, v56
    v_dot2c_f32_bf16 v23, v111, v253
    s_waitcnt vmcnt(8)
    s_cmp_lt_u32 s38, 1
    s_cbranch_scc1 Lfb94
    s_waitcnt vmcnt(7)
    s_cmp_lt_u32 s38, 2
    s_cbranch_scc1 Lfb94
    s_waitcnt vmcnt(1)
Lfb94:
    buffer_load_dwordx4 v[92:95], v2, s[48:51], s10 offen offset:256 nt
    v_dot2c_f32_bf16 v24, v112, v56
    v_dot2c_f32_bf16 v25, v112, v253
    v_dot2c_f32_bf16 v26, v113, v56
    v_dot2c_f32_bf16 v27, v113, v253
    v_dot2c_f32_bf16 v28, v114, v56
    v_dot2c_f32_bf16 v29, v114, v253
    v_dot2c_f32_bf16 v30, v115, v56
    v_dot2c_f32_bf16 v31, v115, v253
    s_barrier
    s_xor_b32 s80, s75, 38
    v_mov_b32 v9, s80
    s_mov_b64 exec, 1
    buffer_store_dword v9, v5, s[76:79], s39 offen
    s_lshr_b32 s80, s7, 5
    s_lshl_b32 s80, s80, 8
    s_add_u32 s80, s80, 40960
    s_mov_b32 exec_lo, -1
    buffer_load_dword v254, v5, s[76:79], s80 offen sc1
    s_mov_b64 exec, -1
    s_nop 0
    s_add_u32 s10, s9, 1179648
    s_cmp_ge_u32 s10, s8
    s_cselect_b32 s83, 3145728, 0
    s_sub_u32 s10, s10, s83
    s_waitcnt vmcnt(10)
    s_cmp_lt_u32 s38, 1
    s_cbranch_scc1 Lfb95
    s_waitcnt vmcnt(4)
    s_cmp_lt_u32 s38, 2
    s_cbranch_scc1 Lfb95
    s_waitcnt vmcnt(3)
Lfb95:
    buffer_load_dwordx4 v[96:99], v2, s[48:51], s10 offen offset:0 nt
    v_dot2c_f32_bf16 v32, v116, v56
    v_dot2c_f32_bf16 v33, v116, v253
    v_dot2c_f32_bf16 v34, v117, v56
    v_dot2c_f32_bf16 v35, v117, v253
    v_dot2c_f32_bf16 v36, v118, v56
    v_dot2c_f32_bf16 v37, v118, v253
    v_dot2c_f32_bf16 v38, v119, v56
    v_dot2c_f32_bf16 v39, v119, v253
    s_waitcnt vmcnt(5)
    s_cmp_lt_u32 s38, 1
    s_cbranch_scc1 Lfb96
    s_waitcnt vmcnt(4)
    s_cmp_lt_u32 s38, 2
    s_cbranch_scc1 Lfb96
    s_waitcnt vmcnt(3)
Lfb96:
    buffer_load_dwordx4 v[100:103], v2, s[48:51], s10 offen offset:128 nt
    v_perm_b32 v252, v156, v152, s20
    v_perm_b32 v156, v156, v152, s21
    v_perm_b32 v152, v157, v153, s20
    v_perm_b32 v157, v157, v153, s21
    v_perm_b32 v153, v158, v154, s20
    v_perm_b32 v158, v158, v154, s21
    v_perm_b32 v154, v159, v155, s20
    v_perm_b32 v159, v159, v155, s21
    v_perm_b32 v155, v161, v160, s20
    v_perm_b32 v161, v161, v160, s21
    v_mov_b32 v160, v252
    v_lshlrev_b32 v253, 16, v57
    v_dot2c_f32_bf16 v16, v84, v57
    v_dot2c_f32_bf16 v17, v84, v253
    v_dot2c_f32_bf16 v18, v85, v57
    v_dot2c_f32_bf16 v19, v85, v253
    v_dot2c_f32_bf16 v20, v86, v57
    v_dot2c_f32_bf16 v21, v86, v253
    v_dot2c_f32_bf16 v22, v87, v57
    v_dot2c_f32_bf16 v23, v87, v253
    s_waitcnt vmcnt(5)
    s_cmp_lt_u32 s38, 1
    s_cbranch_scc1 Lfb97
    s_waitcnt vmcnt(4)
    s_cmp_lt_u32 s38, 2
    s_cbranch_scc1 Lfb97
    s_waitcnt vmcnt(1)
Lfb97:
    buffer_load_dwordx4 v[104:107], v2, s[48:51], s10 offen offset:256 nt
    v_dot2c_f32_bf16 v24, v88, v57
    v_dot2c_f32_bf16 v25, v88, v253
    v_dot2c_f32_bf16 v26, v89, v57
    v_dot2c_f32_bf16 v27, v89, v253
    v_dot2c_f32_bf16 v28, v90, v57
    v_dot2c_f32_bf16 v29, v90, v253
    v_dot2c_f32_bf16 v30, v91, v57
    v_dot2c_f32_bf16 v31, v91, v253
    s_add_u32 s10, s12, 168960
    buffer_load_dwordx4 v[142:145], v4, s[56:59], s10 offen offset:0
    buffer_load_dword v150, v5, s[56:59], s10 offen offset:1024
    buffer_load_dwordx4 v[146:149], v4, s[56:59], s10 offen offset:1280
    buffer_load_dword v151, v5, s[56:59], s10 offen offset:2304
    v_and_b32 v9, 7, v1
    v_lshlrev_b32 v9, 7, v9
    v_bfe_u32 v56, v1, 4, 1
    v_lshl_add_u32 v9, v56, 4, v9
    s_andn2_b32 s80, s7, 7
    s_lshl_b32 s80, s80, 7
    s_add_u32 s80, s80, 4096
    s_cmp_eq_u32 s3, 1
    s_cselect_b32 s80, s80, 1073741824
    v_add_u32 v56, s80, v9
    buffer_load_dwordx4 v[52:55], v56, s[76:79], 0 offen sc1
    s_xor_b32 s80, s75, 39
    v_mov_b32 v9, s80
    s_mov_b64 exec, 1
    buffer_store_dword v9, v5, s[76:79], s39 offen
    s_mov_b64 exec, -1
    s_nop 0
    s_add_u32 s10, s9, 1376256
    s_cmp_ge_u32 s10, s8
    s_cselect_b32 s83, 3145728, 0
    s_sub_u32 s10, s10, s83
    s_waitcnt vmcnt(11)
    s_cmp_lt_u32 s38, 1
    s_cbranch_scc1 Lfb98
    s_waitcnt vmcnt(8)
    s_cmp_lt_u32 s38, 2
    s_cbranch_scc1 Lfb98
    s_waitcnt vmcnt(7)
Lfb98:
    buffer_load_dwordx4 v[108:111], v2, s[48:51], s10 offen offset:0 nt
    v_dot2c_f32_bf16 v32, v92, v57
    v_dot2c_f32_bf16 v33, v92, v253
    v_dot2c_f32_bf16 v34, v93, v57
    v_dot2c_f32_bf16 v35, v93, v253
    v_dot2c_f32_bf16 v36, v94, v57
    v_dot2c_f32_bf16 v37, v94, v253
    v_dot2c_f32_bf16 v38, v95, v57
    v_dot2c_f32_bf16 v39, v95, v253
    s_waitcnt vmcnt(9)
    s_cmp_lt_u32 s38, 1
    s_cbranch_scc1 Lfb99
    s_waitcnt vmcnt(8)
    s_cmp_lt_u32 s38, 2
    s_cbranch_scc1 Lfb99
    s_waitcnt vmcnt(7)
Lfb99:
    buffer_load_dwordx4 v[112:115], v2, s[48:51], s10 offen offset:128 nt
    v_xor_b32 v9, s75, v254
    v_min_u32 v9, 64, v9
    s_and_b32 s80, s7, 31
    s_nop 1
    v_readlane_b32 s81, v9, s80
    s_nop 1
    v_cmp_gt_u32 vcc, s81, v9
    s_nop 1
    s_bcnt1_i32_b32 s82, vcc_lo
    v_cmp_lt_u32 vcc, s81, v9
    s_nop 1
    s_bcnt1_i32_b32 s83, vcc_lo
    s_sub_i32 s82, s82, s83
    v_cmp_eq_u32 vcc, 64, v9
    s_nop 1
    s_bcnt1_i32_b32 s83, vcc_lo
    s_add_i32 s82, s82, s83
    s_cmp_gt_i32 s82, 99
    s_cselect_b32 s38, 2, 1
    s_cmp_lt_i32 s82, -4
    s_cselect_b32 s38, 0, s38
    v_lshlrev_b32 v253, 16, v58
    v_dot2c_f32_bf16 v16, v96, v58
    v_dot2c_f32_bf16 v17, v96, v253
    v_dot2c_f32_bf16 v18, v97, v58
    v_dot2c_f32_bf16 v19, v97, v253
    v_dot2c_f32_bf16 v20, v98, v58
    v_dot2c_f32_bf16 v21, v98, v253
    v_dot2c_f32_bf16 v22, v99, v58
    v_dot2c_f32_bf16 v23, v99, v253
    s_waitcnt vmcnt(9)
    s_cmp_lt_u32 s38, 1
    s_cbranch_scc1 Lfb100
    s_waitcnt vmcnt(8)
    s_cmp_lt_u32 s38, 2
    s_cbranch_scc1 Lfb100
    s_waitcnt vmcnt(1)
Lfb100:
    buffer_load_dwordx4 v[116:119], v2, s[48:51], s10 offen offset:256 nt
    v_dot2c_f32_bf16 v24, v100, v58
    v_dot2c_f32_bf16 v25, v100, v253
    v_dot2c_f32_bf16 v26, v101, v58
    v_dot2c_f32_bf16 v27, v101, v253
    v_dot2c_f32_bf16 v28, v102, v58
    v_dot2c_f32_bf16 v29, v102, v253
    v_dot2c_f32_bf16 v30, v103, v58
    v_dot2c_f32_bf16 v31, v103, v253
    s_barrier
    s_xor_b32 s80, s75, 40
    v_mov_b32 v9, s80
    s_mov_b64 exec, 1
    buffer_store_dword v9, v5, s[76:79], s39 offen
    s_mov_b64 exec, -1
    s_nop 0
    s_add_u32 s10, s9, 1572864
    s_cmp_ge_u32 s10, s8
    s_cselect_b32 s83, 3145728, 0
    s_sub_u32 s10, s10, s83
    s_waitcnt vmcnt(10)
    s_cmp_lt_u32 s38, 1
    s_cbranch_scc1 Lfb101
    s_waitcnt vmcnt(3)
    s_cmp_lt_u32 s38, 2
    s_cbranch_scc1 Lfb101
    s_waitcnt vmcnt(2)
Lfb101:
    buffer_load_dwordx4 v[84:87], v2, s[48:51], s10 offen offset:0 nt
    v_dot2c_f32_bf16 v32, v104, v58
    v_dot2c_f32_bf16 v33, v104, v253
    v_dot2c_f32_bf16 v34, v105, v58
    v_dot2c_f32_bf16 v35, v105, v253
    v_dot2c_f32_bf16 v36, v106, v58
    v_dot2c_f32_bf16 v37, v106, v253
    v_dot2c_f32_bf16 v38, v107, v58
    v_dot2c_f32_bf16 v39, v107, v253
    s_waitcnt vmcnt(4)
    s_cmp_lt_u32 s38, 1
    s_cbranch_scc1 Lfb102
    s_waitcnt vmcnt(3)
    s_cmp_lt_u32 s38, 2
    s_cbranch_scc1 Lfb102
    s_waitcnt vmcnt(2)
Lfb102:
    buffer_load_dwordx4 v[88:91], v2, s[48:51], s10 offen offset:128 nt
    v_perm_b32 v252, v146, v142, s20
    v_perm_b32 v146, v146, v142, s21
    v_perm_b32 v142, v147, v143, s20
    v_perm_b32 v147, v147, v143, s21
    v_perm_b32 v143, v148, v144, s20
    v_perm_b32 v148, v148, v144, s21
    v_perm_b32 v144, v149, v145, s20
    v_perm_b32 v149, v149, v145, s21
    v_perm_b32 v145, v151, v150, s20
    v_perm_b32 v151, v151, v150, s21
    v_mov_b32 v150, v252
    v_lshlrev_b32 v253, 16, v59
    v_dot2c_f32_bf16 v16, v108, v59
    v_dot2c_f32_bf16 v17, v108, v253
    v_dot2c_f32_bf16 v18, v109, v59
    v_dot2c_f32_bf16 v19, v109, v253
    v_dot2c_f32_bf16 v20, v110, v59
    v_dot2c_f32_bf16 v21, v110, v253
    v_dot2c_f32_bf16 v22, v111, v59
    v_dot2c_f32_bf16 v23, v111, v253
    s_cmp_lg_u32 s3, 1
    s_cbranch_scc1 Lm_skip
    v_xor_b32 v9, s75, v55
    v_cmp_ne_u32 vcc, s75, v53
    v_cmp_lt_u32 s[80:81], 15, v9
    s_nop 0
    s_or_b64 vcc, vcc, s[80:81]
    s_cbranch_scc1 Lm_slow
Lm_ok:
    s_nop 0
    v_cmp_ne_u32 vcc, s33, v55
    s_nop 0
    s_cmp_eq_u64 vcc, 0
    s_cselect_b32 s32, 1, 0
    s_cbranch_scc0 Lm_far
Lm_back:
    v_max_f32_dpp v53, v52, v52 quad_perm:[1,0,3,2] row_mask:0xf bank_mask:0xf
    s_nop 1
    v_max_f32_dpp v53, v53, v53 quad_perm:[2,3,0,1] row_mask:0xf bank_mask:0xf
    s_nop 1
    v_max_f32_dpp v53, v53, v53 row_half_mirror row_mask:0xf bank_mask:0xf
    v_sub_f32 v53, v52, v53
    v_mul_f32 v53, s15, v53
    v_exp_f32 v53, v53
    s_nop 0
    v_mul_f32 v55, v53, v54
    s_nop 1
    v_add_f32_dpp v55, v55, v55 quad_perm:[1,0,3,2] row_mask:0xf bank_mask:0xf
    s_nop 1
    v_add_f32_dpp v55, v55, v55 quad_perm:[2,3,0,1] row_mask:0xf bank_mask:0xf
    s_nop 1
    v_add_f32_dpp v55, v55, v55 row_half_mirror row_mask:0xf bank_mask:0xf
    v_rcp_f32 v55, v55
    s_nop 0
    v_mul_f32 v53, v53, v55
    v_lshlrev_b32 v55, 2, v1
    ds_write_b32 v55, v53 offset:9216
Lm_skip:
    s_waitcnt vmcnt(4)
    s_cmp_lt_u32 s38, 1
    s_cbranch_scc1 Lfb103
    s_waitcnt vmcnt(3)
    s_cmp_lt_u32 s38, 2
    s_cbranch_scc1 Lfb103
    s_waitcnt vmcnt(1)
Lfb103:
    buffer_load_dwordx4 v[92:95], v2, s[48:51], s10 offen offset:256 nt
    v_dot2c_f32_bf16 v24, v112, v59
    v_dot2c_f32_bf16 v25, v112, v253
    v_dot2c_f32_bf16 v26, v113, v59
    v_dot2c_f32_bf16 v27, v113, v253
    v_dot2c_f32_bf16 v28, v114, v59
    v_dot2c_f32_bf16 v29, v114, v253
    v_dot2c_f32_bf16 v30, v115, v59
    v_dot2c_f32_bf16 v31, v115, v253
    s_waitcnt lgkmcnt(0)
    s_barrier
    s_add_u32 s10, s12, 171520
    buffer_load_dwordx4 v[132:135], v4, s[56:59], s10 offen offset:0
    buffer_load_dword v140, v5, s[56:59], s10 offen offset:1024
    buffer_load_dwordx4 v[136:139], v4, s[56:59], s10 offen offset:1280
    buffer_load_dword v141, v5, s[56:59], s10 offen offset:2304
    v_and_b32 v9, 3, v1
    v_lshlrev_b32 v9, 6, v9
    s_lshl_b32 s80, s6, 2
    v_add_u32 v9, s80, v9
    ds_read_b32 v9, v9 offset:9216
    s_waitcnt lgkmcnt(0)
    v_mul_f32 v14, s28, v9
    v_mul_f32 v9, s29, v9
    v_readlane_b32 s28, v14, 0
    v_readlane_b32 s29, v9, 1
    s_xor_b32 s80, s75, 41
    v_mov_b32 v9, s80
    s_mov_b64 exec, 1
    buffer_store_dword v9, v5, s[76:79], s39 offen
    s_mov_b64 exec, -1
    s_nop 0
    s_add_u32 s10, s9, 1769472
    s_cmp_ge_u32 s10, s8
    s_cselect_b32 s83, 3145728, 0
    s_sub_u32 s10, s10, s83
    s_waitcnt vmcnt(9)
    s_cmp_lt_u32 s38, 1
    s_cbranch_scc1 Lfb104
    s_waitcnt vmcnt(7)
    s_cmp_lt_u32 s38, 2
    s_cbranch_scc1 Lfb104
    s_waitcnt vmcnt(6)
Lfb104:
    buffer_load_dwordx4 v[96:99], v2, s[48:51], s10 offen offset:0 nt
    v_dot2c_f32_bf16 v32, v116, v59
    v_dot2c_f32_bf16 v33, v116, v253
    v_dot2c_f32_bf16 v34, v117, v59
    v_dot2c_f32_bf16 v35, v117, v253
    v_dot2c_f32_bf16 v36, v118, v59
    v_dot2c_f32_bf16 v37, v118, v253
    v_dot2c_f32_bf16 v38, v119, v59
    v_dot2c_f32_bf16 v39, v119, v253
    s_waitcnt vmcnt(8)
    s_cmp_lt_u32 s38, 1
    s_cbranch_scc1 Lfb105
    s_waitcnt vmcnt(7)
    s_cmp_lt_u32 s38, 2
    s_cbranch_scc1 Lfb105
    s_waitcnt vmcnt(6)
Lfb105:
    buffer_load_dwordx4 v[100:103], v2, s[48:51], s10 offen offset:128 nt
    v_lshlrev_b32 v253, 16, v60
    v_dot2c_f32_bf16 v16, v84, v60
    v_dot2c_f32_bf16 v17, v84, v253
    v_dot2c_f32_bf16 v18, v85, v60
    v_dot2c_f32_bf16 v19, v85, v253
    v_dot2c_f32_bf16 v20, v86, v60
    v_dot2c_f32_bf16 v21, v86, v253
    v_dot2c_f32_bf16 v22, v87, v60
    v_dot2c_f32_bf16 v23, v87, v253
    s_waitcnt vmcnt(8)
    s_cmp_lt_u32 s38, 1
    s_cbranch_scc1 Lfb106
    s_waitcnt vmcnt(7)
    s_cmp_lt_u32 s38, 2
    s_cbranch_scc1 Lfb106
    s_waitcnt vmcnt(1)
Lfb106:
    buffer_load_dwordx4 v[104:107], v2, s[48:51], s10 offen offset:256 nt
    v_dot2c_f32_bf16 v24, v88, v60
    v_dot2c_f32_bf16 v25, v88, v253
    v_dot2c_f32_bf16 v26, v89, v60
    v_dot2c_f32_bf16 v27, v89, v253
    v_dot2c_f32_bf16 v28, v90, v60
    v_dot2c_f32_bf16 v29, v90, v253
    v_dot2c_f32_bf16 v30, v91, v60
    v_dot2c_f32_bf16 v31, v91, v253
    s_barrier
    s_xor_b32 s80, s75, 42
    v_mov_b32 v9, s80
    s_mov_b64 exec, 1
    buffer_store_dword v9, v5, s[76:79], s39 offen
    s_mov_b64 exec, -1
    s_nop 0
    s_add_u32 s10, s9, 1966080
    s_cmp_ge_u32 s10, s8
    s_cselect_b32 s83, 3145728, 0
    s_sub_u32 s10, s10, s83
    s_waitcnt vmcnt(9)
    s_cmp_lt_u32 s38, 1
    s_cbranch_scc1 Lfb107
    s_waitcnt vmcnt(3)
    s_cmp_lt_u32 s38, 2
    s_cbranch_scc1 Lfb107
    s_waitcnt vmcnt(2)
Lfb107:
    buffer_load_dwordx4 v[108:111], v2, s[48:51], s10 offen offset:0 nt
    v_dot2c_f32_bf16 v32, v92, v60
    v_dot2c_f32_bf16 v33, v92, v253
    v_dot2c_f32_bf16 v34, v93, v60
    v_dot2c_f32_bf16 v35, v93, v253
    v_dot2c_f32_bf16 v36, v94, v60
    v_dot2c_f32_bf16 v37, v94, v253
    v_dot2c_f32_bf16 v38, v95, v60
    v_dot2c_f32_bf16 v39, v95, v253
    s_waitcnt vmcnt(4)
    s_cmp_lt_u32 s38, 1
    s_cbranch_scc1 Lfb108
    s_waitcnt vmcnt(3)
    s_cmp_lt_u32 s38, 2
    s_cbranch_scc1 Lfb108
    s_waitcnt vmcnt(2)
Lfb108:
    buffer_load_dwordx4 v[112:115], v2, s[48:51], s10 offen offset:128 nt
    v_perm_b32 v252, v136, v132, s20
    v_perm_b32 v136, v136, v132, s21
    v_perm_b32 v132, v137, v133, s20
    v_perm_b32 v137, v137, v133, s21
    v_perm_b32 v133, v138, v134, s20
    v_perm_b32 v138, v138, v134, s21
    v_perm_b32 v134, v139, v135, s20
    v_perm_b32 v139, v139, v135, s21
    v_perm_b32 v135, v141, v140, s20
    v_perm_b32 v141, v141, v140, s21
    v_mov_b32 v140, v252
    v_lshlrev_b32 v253, 16, v61
    v_dot2c_f32_bf16 v16, v96, v61
    v_dot2c_f32_bf16 v17, v96, v253
    v_dot2c_f32_bf16 v18, v97, v61
    v_dot2c_f32_bf16 v19, v97, v253
    v_dot2c_f32_bf16 v20, v98, v61
    v_dot2c_f32_bf16 v21, v98, v253
    v_dot2c_f32_bf16 v22, v99, v61
    v_dot2c_f32_bf16 v23, v99, v253
    s_waitcnt vmcnt(4)
    s_cmp_lt_u32 s38, 1
    s_cbranch_scc1 Lfb109
    s_waitcnt vmcnt(3)
    s_cmp_lt_u32 s38, 2
    s_cbranch_scc1 Lfb109
    s_waitcnt vmcnt(1)
Lfb109:
    buffer_load_dwordx4 v[116:119], v2, s[48:51], s10 offen offset:256 nt
    v_dot2c_f32_bf16 v24, v100, v61
    v_dot2c_f32_bf16 v25, v100, v253
    v_dot2c_f32_bf16 v26, v101, v61
    v_dot2c_f32_bf16 v27, v101, v253
    v_dot2c_f32_bf16 v28, v102, v61
    v_dot2c_f32_bf16 v29, v102, v253
    v_dot2c_f32_bf16 v30, v103, v61
    v_dot2c_f32_bf16 v31, v103, v253
    v_lshrrev_b32 v60, 2, v1
    v_cmp_gt_u32 vcc, 3, v60
    v_lshlrev_b32 v60, 9, v60
    v_and_b32 v9, 3, v1
    v_lshl_add_u32 v60, v9, 4, v60
    v_mov_b32 v9, 1073741824
    v_cndmask_b32 v60, v9, v60, vcc
    s_cmp_eq_u32 s100, 1
    s_cselect_b32 s82, 0, 1073741824
    s_lshr_b32 s80, s43, 8
    s_mul_i32 s80, s80, 24
    s_mul_i32 s81, s3, 3
    s_add_u32 s80, s80, s81
    s_lshl_b32 s80, s80, 9
    s_lshl_b32 s81, s42, 8
    s_add_u32 s80, s80, s81
    s_and_b32 s81, s43, 0xc0
    s_add_u32 s80, s80, s81
    s_add_u32 s80, s80, s82
    s_add_u32 s80, s80, 196608
    v_add_u32 v60, s80, v60
    buffer_load_dwordx4 v[56:59], v60, s[76:79], 0 offen sc1
    s_mov_b32 s52, s34
    s_mov_b32 s53, s35
    s_mov_b32 s54, 1280
    s_mov_b32 s55, 0x20000
    s_mov_b32 s64, s36
    s_mov_b32 s65, s37
    s_mov_b32 s66, 2560
    s_mov_b32 s67, 0x20000
    v_and_b32 v9, 15, v1
    v_lshlrev_b32 v9, 1, v9
    s_lshr_b32 s80, s43, 1
    s_add_u32 s80, s80, s82
    s_mul_i32 s81, s42, 1280
    s_add_u32 s81, s81, s80
    buffer_load_ushort v255, v9, s[52:55], s80 offen
    buffer_load_ushort v254, v9, s[60:63], s81 offen
    s_xor_b32 s80, s75, 43
    v_mov_b32 v9, s80
    s_mov_b64 exec, 1
    buffer_store_dword v9, v5, s[76:79], s39 offen
    s_mov_b64 exec, -1
    s_nop 0
    s_add_u32 s10, s9, 2162688
    s_cmp_ge_u32 s10, s8
    s_cselect_b32 s83, 3145728, 0
    s_sub_u32 s10, s10, s83
    s_waitcnt vmcnt(8)
    s_cmp_lt_u32 s38, 1
    s_cbranch_scc1 Lfb110
    s_waitcnt vmcnt(6)
    s_cmp_lt_u32 s38, 2
    s_cbranch_scc1 Lfb110
    s_waitcnt vmcnt(5)
Lfb110:
    buffer_load_dwordx4 v[84:87], v2, s[48:51], s10 offen offset:0 nt
    v_dot2c_f32_bf16 v32, v104, v61
    v_dot2c_f32_bf16 v33, v104, v253
    v_dot2c_f32_bf16 v34, v105, v61
    v_dot2c_f32_bf16 v35, v105, v253
    v_dot2c_f32_bf16 v36, v106, v61
    v_dot2c_f32_bf16 v37, v106, v253
    v_dot2c_f32_bf16 v38, v107, v61
    v_dot2c_f32_bf16 v39, v107, v253
    s_waitcnt vmcnt(7)
    s_cmp_lt_u32 s38, 1
    s_cbranch_scc1 Lfb111
    s_waitcnt vmcnt(6)
    s_cmp_lt_u32 s38, 2
    s_cbranch_scc1 Lfb111
    s_waitcnt vmcnt(5)
Lfb111:
    buffer_load_dwordx4 v[88:91], v2, s[48:51], s10 offen offset:128 nt
    v_lshlrev_b32 v253, 16, v62
    v_dot2c_f32_bf16 v16, v108, v62
    v_dot2c_f32_bf16 v17, v108, v253
    v_dot2c_f32_bf16 v18, v109, v62
    v_dot2c_f32_bf16 v19, v109, v253
    v_dot2c_f32_bf16 v20, v110, v62
    v_dot2c_f32_bf16 v21, v110, v253
    v_dot2c_f32_bf16 v22, v111, v62
    v_dot2c_f32_bf16 v23, v111, v253
    s_waitcnt vmcnt(7)
    s_cmp_lt_u32 s38, 1
    s_cbranch_scc1 Lfb112
    s_waitcnt vmcnt(6)
    s_cmp_lt_u32 s38, 2
    s_cbranch_scc1 Lfb112
    s_waitcnt vmcnt(1)
Lfb112:
    buffer_load_dwordx4 v[92:95], v2, s[48:51], s10 offen offset:256 nt
    v_dot2c_f32_bf16 v24, v112, v62
    v_dot2c_f32_bf16 v25, v112, v253
    v_dot2c_f32_bf16 v26, v113, v62
    v_dot2c_f32_bf16 v27, v113, v253
    v_dot2c_f32_bf16 v28, v114, v62
    v_dot2c_f32_bf16 v29, v114, v253
    v_dot2c_f32_bf16 v30, v115, v62
    v_dot2c_f32_bf16 v31, v115, v253
    s_barrier
    s_xor_b32 s80, s75, 44
    v_mov_b32 v9, s80
    s_mov_b64 exec, 1
    buffer_store_dword v9, v5, s[76:79], s39 offen
    s_mov_b64 exec, -1
    s_nop 0
    s_add_u32 s10, s9, 2359296
    s_cmp_ge_u32 s10, s8
    s_cselect_b32 s83, 3145728, 0
    s_sub_u32 s10, s10, s83
    s_waitcnt vmcnt(8)
    s_cmp_lt_u32 s38, 1
    s_cbranch_scc1 Lfb113
    s_waitcnt vmcnt(3)
    s_cmp_lt_u32 s38, 2
    s_cbranch_scc1 Lfb113
    s_waitcnt vmcnt(2)
Lfb113:
    buffer_load_dwordx4 v[96:99], v2, s[48:51], s10 offen offset:0 nt
    v_dot2c_f32_bf16 v32, v116, v62
    v_dot2c_f32_bf16 v33, v116, v253
    v_dot2c_f32_bf16 v34, v117, v62
    v_dot2c_f32_bf16 v35, v117, v253
    v_dot2c_f32_bf16 v36, v118, v62
    v_dot2c_f32_bf16 v37, v118, v253
    v_dot2c_f32_bf16 v38, v119, v62
    v_dot2c_f32_bf16 v39, v119, v253
    s_waitcnt vmcnt(4)
    s_cmp_lt_u32 s38, 1
    s_cbranch_scc1 Lfb114
    s_waitcnt vmcnt(3)
    s_cmp_lt_u32 s38, 2
    s_cbranch_scc1 Lfb114
    s_waitcnt vmcnt(2)
Lfb114:
    buffer_load_dwordx4 v[100:103], v2, s[48:51], s10 offen offset:128 nt
    v_lshlrev_b32 v253, 16, v63
    v_dot2c_f32_bf16 v16, v84, v63
    v_dot2c_f32_bf16 v17, v84, v253
    v_dot2c_f32_bf16 v18, v85, v63
    v_dot2c_f32_bf16 v19, v85, v253
    v_dot2c_f32_bf16 v20, v86, v63
    v_dot2c_f32_bf16 v21, v86, v253
    v_dot2c_f32_bf16 v22, v87, v63
    v_dot2c_f32_bf16 v23, v87, v253
    v_perm_b32 v9, v57, v56, s72
    v_perm_b32 v14, v59, v58, s72
    v_lshl_or_b32 v9, v14, 16, v9
    v_cmp_ne_u32 vcc, s75, v9
    s_nop 0
    s_and_b64 vcc, vcc, 0xfff
    s_cbranch_scc1 Lg_slow
Lg_ok:
    s_nop 0
    v_and_b32 v56, s73, v56
    v_and_b32 v57, s73, v57
    v_and_b32 v58, s73, v58
    v_and_b32 v59, s73, v59
    s_nop 0
    v_permlane32_swap_b32 v56, v58
    v_permlane32_swap_b32 v57, v59
    v_add_f32 v56, v56, v58
    v_add_f32 v57, v57, v59
    s_nop 1
    v_permlane16_swap_b32 v56, v57
    v_add_f32 v56, v56, v57
    s_nop 1
    v_add_f32_dpp v56, v56, v56 row_ror:8 row_mask:0xf bank_mask:0xf
    s_nop 1
    v_add_f32_dpp v56, v56, v56 row_ror:4 row_mask:0xf bank_mask:0xf
    ds_write_b32 v15, v56 offset:40960
    v_lshl_or_b32 v255, v254, 16, v255
    s_waitcnt vmcnt(4)
    s_cmp_lt_u32 s38, 1
    s_cbranch_scc1 Lfb115
    s_waitcnt vmcnt(3)
    s_cmp_lt_u32 s38, 2
    s_cbranch_scc1 Lfb115
    s_waitcnt vmcnt(1)
Lfb115:
    buffer_load_dwordx4 v[104:107], v2, s[48:51], s10 offen offset:256 nt
    v_dot2c_f32_bf16 v24, v88, v63
    v_dot2c_f32_bf16 v25, v88, v253
    v_dot2c_f32_bf16 v26, v89, v63
    v_dot2c_f32_bf16 v27, v89, v253
    v_dot2c_f32_bf16 v28, v90, v63
    v_dot2c_f32_bf16 v29, v90, v253
    v_dot2c_f32_bf16 v30, v91, v63
    v_dot2c_f32_bf16 v31, v91, v253
    s_xor_b32 s80, s75, 45
    v_mov_b32 v9, s80
    s_mov_b64 exec, 1
    buffer_store_dword v9, v5, s[76:79], s39 offen
    s_mov_b64 exec, -1
    s_nop 0
    s_add_u32 s10, s9, 2555904
    s_cmp_ge_u32 s10, s8
    s_cselect_b32 s83, 3145728, 0
    s_sub_u32 s10, s10, s83
    s_waitcnt vmcnt(5)
    s_cmp_lt_u32 s38, 1
    s_cbranch_scc1 Lfb116
    s_waitcnt vmcnt(3)
    s_cmp_lt_u32 s38, 2
    s_cbranch_scc1 Lfb116
    s_waitcnt vmcnt(2)
Lfb116:
    buffer_load_dwordx4 v[108:111], v2, s[48:51], s10 offen offset:0 nt
    v_dot2c_f32_bf16 v32, v92, v63
    v_dot2c_f32_bf16 v33, v92, v253
    v_dot2c_f32_bf16 v34, v93, v63
    v_dot2c_f32_bf16 v35, v93, v253
    v_dot2c_f32_bf16 v36, v94, v63
    v_dot2c_f32_bf16 v37, v94, v253
    v_dot2c_f32_bf16 v38, v95, v63
    v_dot2c_f32_bf16 v39, v95, v253
    s_waitcnt vmcnt(4)
    s_cmp_lt_u32 s38, 1
    s_cbranch_scc1 Lfb117
    s_waitcnt vmcnt(3)
    s_cmp_lt_u32 s38, 2
    s_cbranch_scc1 Lfb117
    s_waitcnt vmcnt(2)
Lfb117:
    buffer_load_dwordx4 v[112:115], v2, s[48:51], s10 offen offset:128 nt
    v_lshlrev_b32 v253, 16, v64
    v_dot2c_f32_bf16 v16, v96, v64
    v_dot2c_f32_bf16 v17, v96, v253
    v_dot2c_f32_bf16 v18, v97, v64
    v_dot2c_f32_bf16 v19, v97, v253
    v_dot2c_f32_bf16 v20, v98, v64
    v_dot2c_f32_bf16 v21, v98, v253
    v_dot2c_f32_bf16 v22, v99, v64
    v_dot2c_f32_bf16 v23, v99, v253
    s_waitcnt vmcnt(4)
    s_cmp_lt_u32 s38, 1
    s_cbranch_scc1 Lfb118
    s_waitcnt vmcnt(3)
    s_cmp_lt_u32 s38, 2
    s_cbranch_scc1 Lfb118
    s_waitcnt vmcnt(1)
Lfb118:
    buffer_load_dwordx4 v[116:119], v2, s[48:51], s10 offen offset:256 nt
    v_dot2c_f32_bf16 v24, v100, v64
    v_dot2c_f32_bf16 v25, v100, v253
    v_dot2c_f32_bf16 v26, v101, v64
    v_dot2c_f32_bf16 v27, v101, v253
    v_dot2c_f32_bf16 v28, v102, v64
    v_dot2c_f32_bf16 v29, v102, v253
    v_dot2c_f32_bf16 v30, v103, v64
    v_dot2c_f32_bf16 v31, v103, v253
    s_barrier
    s_xor_b32 s80, s75, 46
    v_mov_b32 v9, s80
    s_mov_b64 exec, 1
    buffer_store_dword v9, v5, s[76:79], s39 offen
    s_lshr_b32 s80, s7, 5
    s_lshl_b32 s80, s80, 8
    s_add_u32 s80, s80, 40960
    s_mov_b32 exec_lo, -1
    buffer_load_dword v254, v5, s[76:79], s80 offen sc1
    s_mov_b64 exec, -1
    s_nop 0
    s_add_u32 s10, s9, 2752512
    s_cmp_ge_u32 s10, s8
    s_cselect_b32 s83, 3145728, 0
    s_sub_u32 s10, s10, s83
    s_waitcnt vmcnt(6)
    s_cmp_lt_u32 s38, 1
    s_cbranch_scc1 Lfb119
    s_waitcnt vmcnt(4)
    s_cmp_lt_u32 s38, 2
    s_cbranch_scc1 Lfb119
    s_waitcnt vmcnt(3)
Lfb119:
    buffer_load_dwordx4 v[84:87], v2, s[48:51], s10 offen offset:0 nt
    v_dot2c_f32_bf16 v32, v104, v64
    v_dot2c_f32_bf16 v33, v104, v253
    v_dot2c_f32_bf16 v34, v105, v64
    v_dot2c_f32_bf16 v35, v105, v253
    v_dot2c_f32_bf16 v36, v106, v64
    v_dot2c_f32_bf16 v37, v106, v253
    v_dot2c_f32_bf16 v38, v107, v64
    v_dot2c_f32_bf16 v39, v107, v253
    s_waitcnt vmcnt(5)
    s_cmp_lt_u32 s38, 1
    s_cbranch_scc1 Lfb120
    s_waitcnt vmcnt(4)
    s_cmp_lt_u32 s38, 2
    s_cbranch_scc1 Lfb120
    s_waitcnt vmcnt(3)
Lfb120:
    buffer_load_dwordx4 v[88:91], v2, s[48:51], s10 offen offset:128 nt
    v_lshlrev_b32 v253, 16, v65
    v_dot2c_f32_bf16 v16, v108, v65
    v_dot2c_f32_bf16 v17, v108, v253
    v_dot2c_f32_bf16 v18, v109, v65
    v_dot2c_f32_bf16 v19, v109, v253
    v_dot2c_f32_bf16 v20, v110, v65
    v_dot2c_f32_bf16 v21, v110, v253
    v_dot2c_f32_bf16 v22, v111, v65
    v_dot2c_f32_bf16 v23, v111, v253
    s_waitcnt vmcnt(5)
    s_cmp_lt_u32 s38, 1
    s_cbranch_scc1 Lfb121
    s_waitcnt vmcnt(4)
    s_cmp_lt_u32 s38, 2
    s_cbranch_scc1 Lfb121
    s_waitcnt vmcnt(1)
Lfb121:
    buffer_load_dwordx4 v[92:95], v2, s[48:51], s10 offen offset:256 nt
    v_dot2c_f32_bf16 v24, v112, v65
    v_dot2c_f32_bf16 v25, v112, v253
    v_dot2c_f32_bf16 v26, v113, v65
    v_dot2c_f32_bf16 v27, v113, v253
    v_dot2c_f32_bf16 v28, v114, v65
    v_dot2c_f32_bf16 v29, v114, v253
    v_dot2c_f32_bf16 v30, v115, v65
    v_dot2c_f32_bf16 v31, v115, v253
    s_xor_b32 s80, s75, 47
    v_mov_b32 v9, s80
    s_mov_b64 exec, 1
    buffer_store_dword v9, v5, s[76:79], s39 offen
    s_mov_b64 exec, -1
    s_nop 0
    s_add_u32 s10, s9, 2949120
    s_cmp_ge_u32 s10, s8
    s_cselect_b32 s83, 3145728, 0
    s_sub_u32 s10, s10, s83
    s_waitcnt vmcnt(6)
    s_cmp_lt_u32 s38, 1
    s_cbranch_scc1 Lfb122
    s_waitcnt vmcnt(3)
    s_cmp_lt_u32 s38, 2
    s_cbranch_scc1 Lfb122
    s_waitcnt vmcnt(2)
Lfb122:
    buffer_load_dwordx4 v[96:99], v2, s[48:51], s10 offen offset:0 nt
    v_dot2c_f32_bf16 v32, v116, v65
    v_dot2c_f32_bf16 v33, v116, v253
    v_dot2c_f32_bf16 v34, v117, v65
    v_dot2c_f32_bf16 v35, v117, v253
    v_dot2c_f32_bf16 v36, v118, v65
    v_dot2c_f32_bf16 v37, v118, v253
    v_dot2c_f32_bf16 v38, v119, v65
    v_dot2c_f32_bf16 v39, v119, v253
    s_waitcnt vmcnt(4)
    s_cmp_lt_u32 s38, 1
    s_cbranch_scc1 Lfb123
    s_waitcnt vmcnt(3)
    s_cmp_lt_u32 s38, 2
    s_cbranch_scc1 Lfb123
    s_waitcnt vmcnt(2)
Lfb123:
    buffer_load_dwordx4 v[100:103], v2, s[48:51], s10 offen offset:128 nt
    v_xor_b32 v9, s75, v254
    v_min_u32 v9, 64, v9
    s_and_b32 s80, s7, 31
    s_nop 1
    v_readlane_b32 s81, v9, s80
    s_nop 1
    v_cmp_gt_u32 vcc, s81, v9
    s_nop 1
    s_bcnt1_i32_b32 s82, vcc_lo
    v_cmp_lt_u32 vcc, s81, v9
    s_nop 1
    s_bcnt1_i32_b32 s83, vcc_lo
    s_sub_i32 s82, s82, s83
    v_cmp_eq_u32 vcc, 64, v9
    s_nop 1
    s_bcnt1_i32_b32 s83, vcc_lo
    s_add_i32 s82, s82, s83
    s_cmp_gt_i32 s82, 99
    s_cselect_b32 s38, 2, 1
    s_cmp_lt_i32 s82, -4
    s_cselect_b32 s38, 0, s38
    v_lshlrev_b32 v253, 16, v66
    v_dot2c_f32_bf16 v16, v84, v66
    v_dot2c_f32_bf16 v17, v84, v253
    v_dot2c_f32_bf16 v18, v85, v66
    v_dot2c_f32_bf16 v19, v85, v253
    v_dot2c_f32_bf16 v20, v86, v66
    v_dot2c_f32_bf16 v21, v86, v253
    v_dot2c_f32_bf16 v22, v87, v66
    v_dot2c_f32_bf16 v23, v87, v253
    s_waitcnt vmcnt(4)
    s_cmp_lt_u32 s38, 1
    s_cbranch_scc1 Lfb124
    s_waitcnt vmcnt(3)
    s_cmp_lt_u32 s38, 2
    s_cbranch_scc1 Lfb124
    s_waitcnt vmcnt(1)
Lfb124:
    buffer_load_dwordx4 v[104:107], v2, s[48:51], s10 offen offset:256 nt
    v_dot2c_f32_bf16 v24, v88, v66
    v_dot2c_f32_bf16 v25, v88, v253
    v_dot2c_f32_bf16 v26, v89, v66
    v_dot2c_f32_bf16 v27, v89, v253
    v_dot2c_f32_bf16 v28, v90, v66
    v_dot2c_f32_bf16 v29, v90, v253
    v_dot2c_f32_bf16 v30, v91, v66
    v_dot2c_f32_bf16 v31, v91, v253
    s_barrier
    s_xor_b32 s80, s75, 48
    v_mov_b32 v9, s80
    s_mov_b64 exec, 1
    buffer_store_dword v9, v5, s[76:79], s39 offen
    s_lshr_b32 s80, s7, 5
    s_lshl_b32 s80, s80, 8
    s_add_u32 s80, s80, 40960
    s_mov_b32 exec_lo, -1
    buffer_load_dword v254, v5, s[76:79], s80 offen sc1
    s_mov_b64 exec, -1
    s_nop 0
    s_add_u32 s10, s9, 0
    s_cmp_ge_u32 s10, s8
    s_cselect_b32 s83, 3145728, 0
    s_sub_u32 s10, s10, s83
    s_add_u32 s10, s10, 100663296
    s_waitcnt vmcnt(6)
    s_cmp_lt_u32 s38, 1
    s_cbranch_scc1 Lfb125
    s_waitcnt vmcnt(4)
    s_cmp_lt_u32 s38, 2
    s_cbranch_scc1 Lfb125
    s_waitcnt vmcnt(3)
Lfb125:
    buffer_load_dwordx4 v[108:111], v2, s[48:51], s10 offen offset:0 nt
    v_dot2c_f32_bf16 v32, v92, v66
    v_dot2c_f32_bf16 v33, v92, v253
    v_dot2c_f32_bf16 v34, v93, v66
    v_dot2c_f32_bf16 v35, v93, v253
    v_dot2c_f32_bf16 v36, v94, v66
    v_dot2c_f32_bf16 v37, v94, v253
    v_dot2c_f32_bf16 v38, v95, v66
    v_dot2c_f32_bf16 v39, v95, v253
    s_waitcnt vmcnt(5)
    s_cmp_lt_u32 s38, 1
    s_cbranch_scc1 Lfb126
    s_waitcnt vmcnt(4)
    s_cmp_lt_u32 s38, 2
    s_cbranch_scc1 Lfb126
    s_waitcnt vmcnt(3)
Lfb126:
    buffer_load_dwordx4 v[112:115], v2, s[48:51], s10 offen offset:128 nt
    v_lshlrev_b32 v253, 16, v67
    v_dot2c_f32_bf16 v16, v96, v67
    v_dot2c_f32_bf16 v17, v96, v253
    v_dot2c_f32_bf16 v18, v97, v67
    v_dot2c_f32_bf16 v19, v97, v253
    v_dot2c_f32_bf16 v20, v98, v67
    v_dot2c_f32_bf16 v21, v98, v253
    v_dot2c_f32_bf16 v22, v99, v67
    v_dot2c_f32_bf16 v23, v99, v253
    v_permlane32_swap_b32 v16, v20
    v_permlane32_swap_b32 v17, v21
    v_permlane32_swap_b32 v18, v22
    v_permlane32_swap_b32 v19, v23
    v_pk_add_f32 v[16:17], v[16:17], v[20:21]
    v_pk_add_f32 v[18:19], v[18:19], v[22:23]
    s_nop 1
    v_permlane16_swap_b32 v16, v18
    v_permlane16_swap_b32 v17, v19
    v_pk_add_f32 v[16:17], v[16:17], v[18:19]
    s_nop 1
    v_add_f32_dpp v18, v16, v16 row_ror:8 row_mask:0xf bank_mask:0x3
    s_nop 1
    v_add_f32_dpp v18, v17, v17 row_ror:8 row_mask:0xf bank_mask:0xc
    v_mul_f32 v9, s28, v18
    ds_write_b32 v10, v9 offset:42048
    v_mov_b64 v[16:17], 0
    v_mov_b64 v[18:19], 0
    v_mov_b64 v[20:21], 0
    v_mov_b64 v[22:23], 0
    s_waitcnt vmcnt(5)
    s_cmp_lt_u32 s38, 1
    s_cbranch_scc1 Lfb127
    s_waitcnt vmcnt(4)
    s_cmp_lt_u32 s38, 2
    s_cbranch_scc1 Lfb127
    s_waitcnt vmcnt(1)
Lfb127:
    buffer_load_dwordx4 v[116:119], v2, s[48:51], s10 offen offset:256 nt
    v_dot2c_f32_bf16 v24, v100, v67
    v_dot2c_f32_bf16 v25, v100, v253
    v_dot2c_f32_bf16 v26, v101, v67
    v_dot2c_f32_bf16 v27, v101, v253
    v_dot2c_f32_bf16 v28, v102, v67
    v_dot2c_f32_bf16 v29, v102, v253
    v_dot2c_f32_bf16 v30, v103, v67
    v_dot2c_f32_bf16 v31, v103, v253
    v_permlane32_swap_b32 v24, v28
    v_permlane32_swap_b32 v25, v29
    v_permlane32_swap_b32 v26, v30
    v_permlane32_swap_b32 v27, v31
    v_pk_add_f32 v[24:25], v[24:25], v[28:29]
    v_pk_add_f32 v[26:27], v[26:27], v[30:31]
    s_nop 1
    v_permlane16_swap_b32 v24, v26
    v_permlane16_swap_b32 v25, v27
    v_pk_add_f32 v[24:25], v[24:25], v[26:27]
    s_nop 1
    v_add_f32_dpp v26, v24, v24 row_ror:8 row_mask:0xf bank_mask:0x3
    s_nop 1
    v_add_f32_dpp v26, v25, v25 row_ror:8 row_mask:0xf bank_mask:0xc
    v_mul_f32 v9, s28, v26
    ds_write_b32 v10, v9 offset:42304
    v_mov_b64 v[24:25], 0
    v_mov_b64 v[26:27], 0
    v_mov_b64 v[28:29], 0
    v_mov_b64 v[30:31], 0
    s_xor_b32 s80, s75, 49
    v_mov_b32 v9, s80
    s_mov_b64 exec, 1
    buffer_store_dword v9, v5, s[76:79], s39 offen
    s_mov_b64 exec, -1
    s_nop 0
    s_add_u32 s10, s9, 196608
    s_cmp_ge_u32 s10, s8
    s_cselect_b32 s83, 3145728, 0
    s_sub_u32 s10, s10, s83
    s_add_u32 s10, s10, 100663296
    s_waitcnt vmcnt(6)
    s_cmp_lt_u32 s38, 1
    s_cbranch_scc1 Lfb128
    s_waitcnt vmcnt(3)
    s_cmp_lt_u32 s38, 2
    s_cbranch_scc1 Lfb128
    s_waitcnt vmcnt(2)
Lfb128:
    buffer_load_dwordx4 v[84:87], v2, s[48:51], s10 offen offset:0 nt
    v_dot2c_f32_bf16 v32, v104, v67
    v_dot2c_f32_bf16 v33, v104, v253
    v_dot2c_f32_bf16 v34, v105, v67
    v_dot2c_f32_bf16 v35, v105, v253
    v_dot2c_f32_bf16 v36, v106, v67
    v_dot2c_f32_bf16 v37, v106, v253
    v_dot2c_f32_bf16 v38, v107, v67
    v_dot2c_f32_bf16 v39, v107, v253
    v_permlane32_swap_b32 v32, v36
    v_permlane32_swap_b32 v33, v37
    v_permlane32_swap_b32 v34, v38
    v_permlane32_swap_b32 v35, v39
    v_pk_add_f32 v[32:33], v[32:33], v[36:37]
    v_pk_add_f32 v[34:35], v[34:35], v[38:39]
    s_nop 1
    v_permlane16_swap_b32 v32, v34
    v_permlane16_swap_b32 v33, v35
    v_pk_add_f32 v[32:33], v[32:33], v[34:35]
    s_nop 1
    v_add_f32_dpp v34, v32, v32 row_ror:8 row_mask:0xf bank_mask:0x3
    s_nop 1
    v_add_f32_dpp v34, v33, v33 row_ror:8 row_mask:0xf bank_mask:0xc
    v_mul_f32 v9, s28, v34
    ds_write_b32 v10, v9 offset:42560
    v_mov_b64 v[32:33], 0
    v_mov_b64 v[34:35], 0
    v_mov_b64 v[36:37], 0
    v_mov_b64 v[38:39], 0
    s_waitcnt vmcnt(4)
    s_cmp_lt_u32 s38, 1
    s_cbranch_scc1 Lfb129
    s_waitcnt vmcnt(3)
    s_cmp_lt_u32 s38, 2
    s_cbranch_scc1 Lfb129
    s_waitcnt vmcnt(2)
Lfb129:
    buffer_load_dwordx4 v[88:91], v2, s[48:51], s10 offen offset:128 nt
    v_xor_b32 v9, s75, v254
    v_min_u32 v9, 64, v9
    s_and_b32 s80, s7, 31
    s_nop 1
    v_readlane_b32 s81, v9, s80
    s_nop 1
    v_cmp_gt_u32 vcc, s81, v9
    s_nop 1
    s_bcnt1_i32_b32 s82, vcc_lo
    v_cmp_lt_u32 vcc, s81, v9
    s_nop 1
    s_bcnt1_i32_b32 s83, vcc_lo
    s_sub_i32 s82, s82, s83
    v_cmp_eq_u32 vcc, 64, v9
    s_nop 1
    s_bcnt1_i32_b32 s83, vcc_lo
    s_add_i32 s82, s82, s83
    s_cmp_gt_i32 s82, 99
    s_cselect_b32 s38, 2, 1
    s_cmp_lt_i32 s82, -4
    s_cselect_b32 s38, 0, s38
    v_lshlrev_b32 v253, 16, v68
    v_dot2c_f32_bf16 v16, v108, v68
    v_dot2c_f32_bf16 v17, v108, v253
    v_dot2c_f32_bf16 v18, v109, v68
    v_dot2c_f32_bf16 v19, v109, v253
    v_dot2c_f32_bf16 v20, v110, v68
    v_dot2c_f32_bf16 v21, v110, v253
    v_dot2c_f32_bf16 v22, v111, v68
    v_dot2c_f32_bf16 v23, v111, v253
    s_waitcnt vmcnt(4)
    s_cmp_lt_u32 s38, 1
    s_cbranch_scc1 Lfb130
    s_waitcnt vmcnt(3)
    s_cmp_lt_u32 s38, 2
    s_cbranch_scc1 Lfb130
    s_waitcnt vmcnt(1)
Lfb130:
    buffer_load_dwordx4 v[92:95], v2, s[48:51], s10 offen offset:256 nt
    v_dot2c_f32_bf16 v24, v112, v68
    v_dot2c_f32_bf16 v25, v112, v253
    v_dot2c_f32_bf16 v26, v113, v68
    v_dot2c_f32_bf16 v27, v113, v253
    v_dot2c_f32_bf16 v28, v114, v68
    v_dot2c_f32_bf16 v29, v114, v253
    v_dot2c_f32_bf16 v30, v115, v68
    v_dot2c_f32_bf16 v31, v115, v253
    s_waitcnt lgkmcnt(0)
    s_barrier
    s_xor_b32 s80, s75, 50
    v_mov_b32 v9, s80
    s_mov_b64 exec, 1
    buffer_store_dword v9, v5, s[76:79], s39 offen
    s_lshr_b32 s80, s7, 5
    s_lshl_b32 s80, s80, 8
    s_add_u32 s80, s80, 40960
    s_mov_b32 exec_lo, -1
    buffer_load_dword v254, v5, s[76:79], s80 offen sc1
    s_mov_b64 exec, -1
    s_nop 0
    s_add_u32 s10, s9, 393216
    s_cmp_ge_u32 s10, s8
    s_cselect_b32 s83, 3145728, 0
    s_sub_u32 s10, s10, s83
    s_add_u32 s10, s10, 100663296
    s_waitcnt vmcnt(6)
    s_cmp_lt_u32 s38, 1
    s_cbranch_scc1 Lfb131
    s_waitcnt vmcnt(4)
    s_cmp_lt_u32 s38, 2
    s_cbranch_scc1 Lfb131
    s_waitcnt vmcnt(3)
Lfb131:
    buffer_load_dwordx4 v[96:99], v2, s[48:51], s10 offen offset:0 nt
    v_dot2c_f32_bf16 v32, v116, v68
    v_dot2c_f32_bf16 v33, v116, v253
    v_dot2c_f32_bf16 v34, v117, v68
    v_dot2c_f32_bf16 v35, v117, v253
    v_dot2c_f32_bf16 v36, v118, v68
    v_dot2c_f32_bf16 v37, v118, v253
    v_dot2c_f32_bf16 v38, v119, v68
    v_dot2c_f32_bf16 v39, v119, v253
    s_mul_i32 s81, s7, 768
    s_add_u32 s81, s81, 1638400
    s_cmp_eq_u32 s3, 1
    s_cselect_b32 s81, s81, 1073741824
    s_mov_b32 exec_hi, 0xffff
    s_cbranch_scc0 Lxp
    ds_read_b128 v[40:43], v4 offset:42048
    ds_read_b128 v[44:47], v4 offset:42848
    ds_read_b128 v[48:51], v4 offset:43648
    ds_read_b128 v[52:55], v4 offset:44448
    ds_read_b128 v[56:59], v4 offset:45248
    ds_read_b128 v[60:63], v4 offset:46048
    ds_read_b128 v[64:67], v4 offset:46848
    s_waitcnt lgkmcnt(5)
    v_pk_add_f32 v[40:41], v[40:41], v[44:45]
    v_pk_add_f32 v[42:43], v[42:43], v[46:47]
    ds_read_b128 v[44:47], v4 offset:47648
    s_waitcnt lgkmcnt(5)
    v_pk_add_f32 v[40:41], v[40:41], v[48:49]
    v_pk_add_f32 v[42:43], v[42:43], v[50:51]
    s_waitcnt lgkmcnt(4)
    v_pk_add_f32 v[40:41], v[40:41], v[52:53]
    v_pk_add_f32 v[42:43], v[42:43], v[54:55]
    s_waitcnt lgkmcnt(3)
    v_pk_add_f32 v[40:41], v[40:41], v[56:57]
    v_pk_add_f32 v[42:43], v[42:43], v[58:59]
    s_waitcnt lgkmcnt(2)
    v_pk_add_f32 v[40:41], v[40:41], v[60:61]
    v_pk_add_f32 v[42:43], v[42:43], v[62:63]
    s_waitcnt lgkmcnt(1)
    v_pk_add_f32 v[40:41], v[40:41], v[64:65]
    v_pk_add_f32 v[42:43], v[42:43], v[66:67]
    s_waitcnt lgkmcnt(0)
    v_pk_add_f32 v[40:41], v[40:41], v[44:45]
    v_pk_add_f32 v[42:43], v[42:43], v[46:47]
    v_mov_b32_sdwa v40, s75 dst_sel:BYTE_0 dst_unused:UNUSED_PRESERVE src0_sel:BYTE_0
    v_mov_b32_sdwa v41, s75 dst_sel:BYTE_0 dst_unused:UNUSED_PRESERVE src0_sel:BYTE_1
    v_mov_b32_sdwa v42, s75 dst_sel:BYTE_0 dst_unused:UNUSED_PRESERVE src0_sel:BYTE_2
    v_mov_b32_sdwa v43, s75 dst_sel:BYTE_0 dst_unused:UNUSED_PRESERVE src0_sel:BYTE_3
    s_nop 0
Lxp:
    s_cmp_eq_u32 s32, 1
    s_cbranch_scc0 Lxs_far
    buffer_store_dwordx4 v[40:43], v4, s[76:79], s81 offen
Lxs_back:
    s_mov_b32 exec_hi, -1
    s_waitcnt vmcnt(6)
    s_cmp_lt_u32 s38, 1
    s_cbranch_scc1 Lfb132
    s_waitcnt vmcnt(5)
    s_cmp_lt_u32 s38, 2
    s_cbranch_scc1 Lfb132
    s_waitcnt vmcnt(4)
Lfb132:
    buffer_load_dwordx4 v[100:103], v2, s[48:51], s10 offen offset:128 nt
    v_lshlrev_b32 v253, 16, v69
    v_dot2c_f32_bf16 v16, v84, v69
    v_dot2c_f32_bf16 v17, v84, v253
    v_dot2c_f32_bf16 v18, v85, v69
    v_dot2c_f32_bf16 v19, v85, v253
    v_dot2c_f32_bf16 v20, v86, v69
    v_dot2c_f32_bf16 v21, v86, v253
    v_dot2c_f32_bf16 v22, v87, v69
    v_dot2c_f32_bf16 v23, v87, v253
    s_waitcnt vmcnt(6)
    s_cmp_lt_u32 s38, 1
    s_cbranch_scc1 Lfb133
    s_waitcnt vmcnt(5)
    s_cmp_lt_u32 s38, 2
    s_cbranch_scc1 Lfb133
    s_waitcnt vmcnt(2)
Lfb133:
    buffer_load_dwordx4 v[104:107], v2, s[48:51], s10 offen offset:256 nt
    v_dot2c_f32_bf16 v24, v88, v69
    v_dot2c_f32_bf16 v25, v88, v253
    v_dot2c_f32_bf16 v26, v89, v69
    v_dot2c_f32_bf16 v27, v89, v253
    v_dot2c_f32_bf16 v28, v90, v69
    v_dot2c_f32_bf16 v29, v90, v253
    v_dot2c_f32_bf16 v30, v91, v69
    v_dot2c_f32_bf16 v31, v91, v253
    s_xor_b32 s80, s75, 51
    v_mov_b32 v9, s80
    s_mov_b64 exec, 1
    buffer_store_dword v9, v5, s[76:79], s39 offen
    s_mov_b64 exec, -1
    s_nop 0
    s_add_u32 s10, s9, 589824
    s_cmp_ge_u32 s10, s8
    s_cselect_b32 s83, 3145728, 0
    s_sub_u32 s10, s10, s83
    s_add_u32 s10, s10, 100663296
    s_waitcnt vmcnt(7)
    s_cmp_lt_u32 s38, 1
    s_cbranch_scc1 Lfb134
    s_waitcnt vmcnt(4)
    s_cmp_lt_u32 s38, 2
    s_cbranch_scc1 Lfb134
    s_waitcnt vmcnt(2)
Lfb134:
    buffer_load_dwordx4 v[108:111], v2, s[48:51], s10 offen offset:0 nt
    v_dot2c_f32_bf16 v32, v92, v69
    v_dot2c_f32_bf16 v33, v92, v253
    v_dot2c_f32_bf16 v34, v93, v69
    v_dot2c_f32_bf16 v35, v93, v253
    v_dot2c_f32_bf16 v36, v94, v69
    v_dot2c_f32_bf16 v37, v94, v253
    v_dot2c_f32_bf16 v38, v95, v69
    v_dot2c_f32_bf16 v39, v95, v253
    s_waitcnt vmcnt(5)
    s_cmp_lt_u32 s38, 1
    s_cbranch_scc1 Lfb135
    s_waitcnt vmcnt(3)
    s_cmp_lt_u32 s38, 2
    s_cbranch_scc1 Lfb135
    s_waitcnt vmcnt(2)
Lfb135:
    buffer_load_dwordx4 v[112:115], v2, s[48:51], s10 offen offset:128 nt
    v_xor_b32 v9, s75, v254
    v_min_u32 v9, 64, v9
    s_and_b32 s80, s7, 31
    s_nop 1
    v_readlane_b32 s81, v9, s80
    s_nop 1
    v_cmp_gt_u32 vcc, s81, v9
    s_nop 1
    s_bcnt1_i32_b32 s82, vcc_lo
    v_cmp_lt_u32 vcc, s81, v9
    s_nop 1
    s_bcnt1_i32_b32 s83, vcc_lo
    s_sub_i32 s82, s82, s83
    v_cmp_eq_u32 vcc, 64, v9
    s_nop 1
    s_bcnt1_i32_b32 s83, vcc_lo
    s_add_i32 s82, s82, s83
    s_cmp_gt_i32 s82, 99
    s_cselect_b32 s38, 2, 1
    s_cmp_lt_i32 s82, -4
    s_cselect_b32 s38, 0, s38
    v_lshlrev_b32 v253, 16, v70
    v_dot2c_f32_bf16 v16, v96, v70
    v_dot2c_f32_bf16 v17, v96, v253
    v_dot2c_f32_bf16 v18, v97, v70
    v_dot2c_f32_bf16 v19, v97, v253
    v_dot2c_f32_bf16 v20, v98, v70
    v_dot2c_f32_bf16 v21, v98, v253
    v_dot2c_f32_bf16 v22, v99, v70
    v_dot2c_f32_bf16 v23, v99, v253
    s_waitcnt vmcnt(4)
    s_cmp_lt_u32 s38, 1
    s_cbranch_scc1 Lfb136
    s_waitcnt vmcnt(3)
    s_cmp_lt_u32 s38, 2
    s_cbranch_scc1 Lfb136
    s_waitcnt vmcnt(1)
Lfb136:
    buffer_load_dwordx4 v[116:119], v2, s[48:51], s10 offen offset:256 nt
    v_dot2c_f32_bf16 v24, v100, v70
    v_dot2c_f32_bf16 v25, v100, v253
    v_dot2c_f32_bf16 v26, v101, v70
    v_dot2c_f32_bf16 v27, v101, v253
    v_dot2c_f32_bf16 v28, v102, v70
    v_dot2c_f32_bf16 v29, v102, v253
    v_dot2c_f32_bf16 v30, v103, v70
    v_dot2c_f32_bf16 v31, v103, v253
    s_barrier
    s_xor_b32 s80, s75, 52
    v_mov_b32 v9, s80
    s_mov_b64 exec, 1
    buffer_store_dword v9, v5, s[76:79], s39 offen
    s_lshr_b32 s80, s7, 5
    s_lshl_b32 s80, s80, 8
    s_add_u32 s80, s80, 40960
    s_mov_b32 exec_lo, -1
    buffer_load_dword v254, v5, s[76:79], s80 offen sc1
    s_mov_b64 exec, -1
    s_nop 0
    s_add_u32 s10, s9, 786432
    s_cmp_ge_u32 s10, s8
    s_cselect_b32 s83, 3145728, 0
    s_sub_u32 s10, s10, s83
    s_add_u32 s10, s10, 100663296
    s_waitcnt vmcnt(6)
    s_cmp_lt_u32 s38, 1
    s_cbranch_scc1 Lfb137
    s_waitcnt vmcnt(4)
    s_cmp_lt_u32 s38, 2
    s_cbranch_scc1 Lfb137
    s_waitcnt vmcnt(3)
Lfb137:
    buffer_load_dwordx4 v[84:87], v2, s[48:51], s10 offen offset:0 nt
    v_dot2c_f32_bf16 v32, v104, v70
    v_dot2c_f32_bf16 v33, v104, v253
    v_dot2c_f32_bf16 v34, v105, v70
    v_dot2c_f32_bf16 v35, v105, v253
    v_dot2c_f32_bf16 v36, v106, v70
    v_dot2c_f32_bf16 v37, v106, v253
    v_dot2c_f32_bf16 v38, v107, v70
    v_dot2c_f32_bf16 v39, v107, v253
    s_waitcnt vmcnt(5)
    s_cmp_lt_u32 s38, 1
    s_cbranch_scc1 Lfb138
    s_waitcnt vmcnt(4)
    s_cmp_lt_u32 s38, 2
    s_cbranch_scc1 Lfb138
    s_waitcnt vmcnt(3)
Lfb138:
    buffer_load_dwordx4 v[88:91], v2, s[48:51], s10 offen offset:128 nt
    v_lshlrev_b32 v253, 16, v71
    v_dot2c_f32_bf16 v16, v108, v71
    v_dot2c_f32_bf16 v17, v108, v253
    v_dot2c_f32_bf16 v18, v109, v71
    v_dot2c_f32_bf16 v19, v109, v253
    v_dot2c_f32_bf16 v20, v110, v71
    v_dot2c_f32_bf16 v21, v110, v253
    v_dot2c_f32_bf16 v22, v111, v71
    v_dot2c_f32_bf16 v23, v111, v253
    s_waitcnt vmcnt(5)
    s_cmp_lt_u32 s38, 1
    s_cbranch_scc1 Lfb139
    s_waitcnt vmcnt(4)
    s_cmp_lt_u32 s38, 2
    s_cbranch_scc1 Lfb139
    s_waitcnt vmcnt(1)
Lfb139:
    buffer_load_dwordx4 v[92:95], v2, s[48:51], s10 offen offset:256 nt
    v_dot2c_f32_bf16 v24, v112, v71
    v_dot2c_f32_bf16 v25, v112, v253
    v_dot2c_f32_bf16 v26, v113, v71
    v_dot2c_f32_bf16 v27, v113, v253
    v_dot2c_f32_bf16 v28, v114, v71
    v_dot2c_f32_bf16 v29, v114, v253
    v_dot2c_f32_bf16 v30, v115, v71
    v_dot2c_f32_bf16 v31, v115, v253
    s_xor_b32 s80, s75, 53
    v_mov_b32 v9, s80
    s_mov_b64 exec, 1
    buffer_store_dword v9, v5, s[76:79], s39 offen
    s_mov_b64 exec, -1
    s_nop 0
    s_add_u32 s10, s9, 983040
    s_cmp_ge_u32 s10, s8
    s_cselect_b32 s83, 3145728, 0
    s_sub_u32 s10, s10, s83
    s_add_u32 s10, s10, 100663296
    s_waitcnt vmcnt(6)
    s_cmp_lt_u32 s38, 1
    s_cbranch_scc1 Lfb140
    s_waitcnt vmcnt(3)
    s_cmp_lt_u32 s38, 2
    s_cbranch_scc1 Lfb140
    s_waitcnt vmcnt(2)
Lfb140:
    buffer_load_dwordx4 v[96:99], v2, s[48:51], s10 offen offset:0 nt
    v_dot2c_f32_bf16 v32, v116, v71
    v_dot2c_f32_bf16 v33, v116, v253
    v_dot2c_f32_bf16 v34, v117, v71
    v_dot2c_f32_bf16 v35, v117, v253
    v_dot2c_f32_bf16 v36, v118, v71
    v_dot2c_f32_bf16 v37, v118, v253
    v_dot2c_f32_bf16 v38, v119, v71
    v_dot2c_f32_bf16 v39, v119, v253
    s_waitcnt vmcnt(4)
    s_cmp_lt_u32 s38, 1
    s_cbranch_scc1 Lfb141
    s_waitcnt vmcnt(3)
    s_cmp_lt_u32 s38, 2
    s_cbranch_scc1 Lfb141
    s_waitcnt vmcnt(2)
Lfb141:
    buffer_load_dwordx4 v[100:103], v2, s[48:51], s10 offen offset:128 nt
    v_xor_b32 v9, s75, v254
    v_min_u32 v9, 64, v9
    s_and_b32 s80, s7, 31
    s_nop 1
    v_readlane_b32 s81, v9, s80
    s_nop 1
    v_cmp_gt_u32 vcc, s81, v9
    s_nop 1
    s_bcnt1_i32_b32 s82, vcc_lo
    v_cmp_lt_u32 vcc, s81, v9
    s_nop 1
    s_bcnt1_i32_b32 s83, vcc_lo
    s_sub_i32 s82, s82, s83
    v_cmp_eq_u32 vcc, 64, v9
    s_nop 1
    s_bcnt1_i32_b32 s83, vcc_lo
    s_add_i32 s82, s82, s83
    s_cmp_gt_i32 s82, 99
    s_cselect_b32 s38, 2, 1
    s_cmp_lt_i32 s82, -4
    s_cselect_b32 s38, 0, s38
    v_lshlrev_b32 v253, 16, v72
    v_dot2c_f32_bf16 v16, v84, v72
    v_dot2c_f32_bf16 v17, v84, v253
    v_dot2c_f32_bf16 v18, v85, v72
    v_dot2c_f32_bf16 v19, v85, v253
    v_dot2c_f32_bf16 v20, v86, v72
    v_dot2c_f32_bf16 v21, v86, v253
    v_dot2c_f32_bf16 v22, v87, v72
    v_dot2c_f32_bf16 v23, v87, v253
    s_waitcnt vmcnt(4)
    s_cmp_lt_u32 s38, 1
    s_cbranch_scc1 Lfb142
    s_waitcnt vmcnt(3)
    s_cmp_lt_u32 s38, 2
    s_cbranch_scc1 Lfb142
    s_waitcnt vmcnt(1)
Lfb142:
    buffer_load_dwordx4 v[104:107], v2, s[48:51], s10 offen offset:256 nt
    v_dot2c_f32_bf16 v24, v88, v72
    v_dot2c_f32_bf16 v25, v88, v253
    v_dot2c_f32_bf16 v26, v89, v72
    v_dot2c_f32_bf16 v27, v89, v253
    v_dot2c_f32_bf16 v28, v90, v72
    v_dot2c_f32_bf16 v29, v90, v253
    v_dot2c_f32_bf16 v30, v91, v72
    v_dot2c_f32_bf16 v31, v91, v253
    s_barrier
    s_andn2_b32 s27, s7, 7
    s_add_u32 s27, s27, s3
    s_mul_i32 s27, s27, 768
    s_add_u32 s27, s27, 1638400
    s_mov_b32 exec_hi, 0xffff
    buffer_load_dwordx4 v[52:55], v4, s[76:79], s27 offen sc1
    s_mov_b32 exec_hi, -1
    s_xor_b32 s80, s75, 54
    v_mov_b32 v9, s80
    s_mov_b64 exec, 1
    buffer_store_dword v9, v5, s[76:79], s39 offen
    s_lshr_b32 s80, s7, 5
    s_lshl_b32 s80, s80, 8
    s_add_u32 s80, s80, 40960
    s_mov_b32 exec_lo, -1
    buffer_load_dword v254, v5, s[76:79], s80 offen sc1
    s_mov_b64 exec, -1
    s_nop 0
    s_add_u32 s10, s9, 1179648
    s_cmp_ge_u32 s10, s8
    s_cselect_b32 s83, 3145728, 0
    s_sub_u32 s10, s10, s83
    s_add_u32 s10, s10, 100663296
    s_waitcnt vmcnt(7)
    s_cmp_lt_u32 s38, 1
    s_cbranch_scc1 Lfb143
    s_waitcnt vmcnt(5)
    s_cmp_lt_u32 s38, 2
    s_cbranch_scc1 Lfb143
    s_waitcnt vmcnt(4)
Lfb143:
    buffer_load_dwordx4 v[108:111], v2, s[48:51], s10 offen offset:0 nt
    v_dot2c_f32_bf16 v32, v92, v72
    v_dot2c_f32_bf16 v33, v92, v253
    v_dot2c_f32_bf16 v34, v93, v72
    v_dot2c_f32_bf16 v35, v93, v253
    v_dot2c_f32_bf16 v36, v94, v72
    v_dot2c_f32_bf16 v37, v94, v253
    v_dot2c_f32_bf16 v38, v95, v72
    v_dot2c_f32_bf16 v39, v95, v253
    s_waitcnt vmcnt(6)
    s_cmp_lt_u32 s38, 1
    s_cbranch_scc1 Lfb144
    s_waitcnt vmcnt(5)
    s_cmp_lt_u32 s38, 2
    s_cbranch_scc1 Lfb144
    s_waitcnt vmcnt(4)
Lfb144:
    buffer_load_dwordx4 v[112:115], v2, s[48:51], s10 offen offset:128 nt
    v_lshlrev_b32 v253, 16, v73
    v_dot2c_f32_bf16 v16, v96, v73
    v_dot2c_f32_bf16 v17, v96, v253
    v_dot2c_f32_bf16 v18, v97, v73
    v_dot2c_f32_bf16 v19, v97, v253
    v_dot2c_f32_bf16 v20, v98, v73
    v_dot2c_f32_bf16 v21, v98, v253
    v_dot2c_f32_bf16 v22, v99, v73
    v_dot2c_f32_bf16 v23, v99, v253
    s_waitcnt vmcnt(6)
    s_cmp_lt_u32 s38, 1
    s_cbranch_scc1 Lfb145
    s_waitcnt vmcnt(5)
    s_cmp_lt_u32 s38, 2
    s_cbranch_scc1 Lfb145
    s_waitcnt vmcnt(1)
Lfb145:
    buffer_load_dwordx4 v[116:119], v2, s[48:51], s10 offen offset:256 nt
    v_dot2c_f32_bf16 v24, v100, v73
    v_dot2c_f32_bf16 v25, v100, v253
    v_dot2c_f32_bf16 v26, v101, v73
    v_dot2c_f32_bf16 v27, v101, v253
    v_dot2c_f32_bf16 v28, v102, v73
    v_dot2c_f32_bf16 v29, v102, v253
    v_dot2c_f32_bf16 v30, v103, v73
    v_dot2c_f32_bf16 v31, v103, v253
    s_xor_b32 s80, s75, 55
    v_mov_b32 v9, s80
    s_mov_b64 exec, 1
    buffer_store_dword v9, v5, s[76:79], s39 offen
    s_mov_b64 exec, -1
    s_nop 0
    s_add_u32 s10, s9, 1376256
    s_cmp_ge_u32 s10, s8
    s_cselect_b32 s83, 3145728, 0
    s_sub_u32 s10, s10, s83
    s_add_u32 s10, s10, 100663296
    s_waitcnt vmcnt(7)
    s_cmp_lt_u32 s38, 1
    s_cbranch_scc1 Lfb146
    s_waitcnt vmcnt(3)
    s_cmp_lt_u32 s38, 2
    s_cbranch_scc1 Lfb146
    s_waitcnt vmcnt(2)
Lfb146:
    buffer_load_dwordx4 v[84:87], v2, s[48:51], s10 offen offset:0 nt
    v_dot2c_f32_bf16 v32, v104, v73
    v_dot2c_f32_bf16 v33, v104, v253
    v_dot2c_f32_bf16 v34, v105, v73
    v_dot2c_f32_bf16 v35, v105, v253
    v_dot2c_f32_bf16 v36, v106, v73
    v_dot2c_f32_bf16 v37, v106, v253
    v_dot2c_f32_bf16 v38, v107, v73
    v_dot2c_f32_bf16 v39, v107, v253
    s_waitcnt vmcnt(4)
    s_cmp_lt_u32 s38, 1
    s_cbranch_scc1 Lfb147
    s_waitcnt vmcnt(3)
    s_cmp_lt_u32 s38, 2
    s_cbranch_scc1 Lfb147
    s_waitcnt vmcnt(2)
Lfb147:
    buffer_load_dwordx4 v[88:91], v2, s[48:51], s10 offen offset:128 nt
    v_xor_b32 v9, s75, v254
    v_min_u32 v9, 64, v9
    s_and_b32 s80, s7, 31
    s_nop 1
    v_readlane_b32 s81, v9, s80
    s_nop 1
    v_cmp_gt_u32 vcc, s81, v9
    s_nop 1
    s_bcnt1_i32_b32 s82, vcc_lo
    v_cmp_lt_u32 vcc, s81, v9
    s_nop 1
    s_bcnt1_i32_b32 s83, vcc_lo
    s_sub_i32 s82, s82, s83
    v_cmp_eq_u32 vcc, 64, v9
    s_nop 1
    s_bcnt1_i32_b32 s83, vcc_lo
    s_add_i32 s82, s82, s83
    s_cmp_gt_i32 s82, 99
    s_cselect_b32 s38, 2, 1
    s_cmp_lt_i32 s82, -4
    s_cselect_b32 s38, 0, s38
    v_lshlrev_b32 v253, 16, v74
    v_dot2c_f32_bf16 v16, v108, v74
    v_dot2c_f32_bf16 v17, v108, v253
    v_dot2c_f32_bf16 v18, v109, v74
    v_dot2c_f32_bf16 v19, v109, v253
    v_dot2c_f32_bf16 v20, v110, v74
    v_dot2c_f32_bf16 v21, v110, v253
    v_dot2c_f32_bf16 v22, v111, v74
    v_dot2c_f32_bf16 v23, v111, v253
    v_perm_b32 v9, v53, v52, s72
    v_perm_b32 v14, v55, v54, s72
    v_lshl_or_b32 v9, v14, 16, v9
    v_cmp_ne_u32 vcc, s75, v9
    s_nop 0
    s_and_b32 vcc_hi, vcc_hi, 0xffff
    s_cmp_lg_u64 vcc, 0
    s_cbranch_scc1 Lx_slow
Lx_ok:
    s_nop 0
    v_and_b32 v52, s73, v52
    v_and_b32 v53, s73, v53
    v_and_b32 v54, s73, v54
    v_and_b32 v55, s73, v55
    s_mul_i32 s80, s3, 800
    v_add_u32 v9, s80, v4
    s_mov_b32 exec_hi, 0xffff
    ds_write_b128 v9, v[52:55] offset:42048
    s_mov_b32 exec_hi, -1
    v_mov_b64 v[40:41], 0
    v_mov_b64 v[42:43], 0
    v_mov_b64 v[44:45], 0
    v_mov_b64 v[46:47], 0
    v_mov_b64 v[48:49], 0
    s_waitcnt lgkmcnt(0)
    v_mov_b64 v[52:53], 0
    v_mov_b64 v[54:55], 0
    v_mov_b64 v[56:57], 0
    v_mov_b64 v[58:59], 0
    v_mov_b64 v[60:61], 0
    s_waitcnt vmcnt(4)
    s_cmp_lt_u32 s38, 1
    s_cbranch_scc1 Lfb148
    s_waitcnt vmcnt(3)
    s_cmp_lt_u32 s38, 2
    s_cbranch_scc1 Lfb148
    s_waitcnt vmcnt(1)
Lfb148:
    buffer_load_dwordx4 v[92:95], v2, s[48:51], s10 offen offset:256 nt
    v_dot2c_f32_bf16 v24, v112, v74
    v_dot2c_f32_bf16 v25, v112, v253
    v_dot2c_f32_bf16 v26, v113, v74
    v_dot2c_f32_bf16 v27, v113, v253
    v_dot2c_f32_bf16 v28, v114, v74
    v_dot2c_f32_bf16 v29, v114, v253
    v_dot2c_f32_bf16 v30, v115, v74
    v_dot2c_f32_bf16 v31, v115, v253
    s_waitcnt lgkmcnt(0)
    s_barrier
    s_xor_b32 s80, s75, 56
    v_mov_b32 v9, s80
    s_mov_b64 exec, 1
    buffer_store_dword v9, v5, s[76:79], s39 offen
    s_lshr_b32 s80, s7, 5
    s_lshl_b32 s80, s80, 8
    s_add_u32 s80, s80, 40960
    s_mov_b32 exec_lo, -1
    buffer_load_dword v254, v5, s[76:79], s80 offen sc1
    s_mov_b64 exec, -1
    s_nop 0
    s_add_u32 s10, s9, 1572864
    s_cmp_ge_u32 s10, s8
    s_cselect_b32 s83, 3145728, 0
    s_sub_u32 s10, s10, s83
    s_add_u32 s10, s10, 100663296
    s_waitcnt vmcnt(6)
    s_cmp_lt_u32 s38, 1
    s_cbranch_scc1 Lfb149
    s_waitcnt vmcnt(4)
    s_cmp_lt_u32 s38, 2
    s_cbranch_scc1 Lfb149
    s_waitcnt vmcnt(3)
Lfb149:
    buffer_load_dwordx4 v[96:99], v2, s[48:51], s10 offen offset:0 nt
    v_dot2c_f32_bf16 v32, v116, v74
    v_dot2c_f32_bf16 v33, v116, v253
    v_dot2c_f32_bf16 v34, v117, v74
    v_dot2c_f32_bf16 v35, v117, v253
    v_dot2c_f32_bf16 v36, v118, v74
    v_dot2c_f32_bf16 v37, v118, v253
    v_dot2c_f32_bf16 v38, v119, v74
    v_dot2c_f32_bf16 v39, v119, v253
    ds_read_b32 v9, v11 offset:42048
    s_waitcnt lgkmcnt(0)
    v_add_f32_dpp v9, v9, v9 quad_perm:[1,0,3,2] row_mask:0xf bank_mask:0xf
    s_nop 1
    v_add_f32_dpp v9, v9, v9 quad_perm:[2,3,0,1] row_mask:0xf bank_mask:0xf
    s_nop 1
    v_add_f32_dpp v9, v9, v9 row_half_mirror row_mask:0xf bank_mask:0xf
    s_nop 1
    v_mov_b32_dpp v14, v9 row_ror:8 row_mask:0xf bank_mask:0xf
    v_cvt_pk_bf16_f32 v9, v9, v14
    s_nop 0
    v_readlane_b32 s16, v9, 0
    v_readlane_b32 s17, v9, 16
    v_readlane_b32 s18, v9, 32
    v_readlane_b32 s19, v9, 48
    s_waitcnt vmcnt(5)
    s_cmp_lt_u32 s38, 1
    s_cbranch_scc1 Lfb150
    s_waitcnt vmcnt(4)
    s_cmp_lt_u32 s38, 2
    s_cbranch_scc1 Lfb150
    s_waitcnt vmcnt(3)
Lfb150:
    buffer_load_dwordx4 v[100:103], v2, s[48:51], s10 offen offset:128 nt
    v_lshlrev_b32 v253, 16, v75
    v_dot2c_f32_bf16 v16, v84, v75
    v_dot2c_f32_bf16 v17, v84, v253
    v_dot2c_f32_bf16 v18, v85, v75
    v_dot2c_f32_bf16 v19, v85, v253
    v_dot2c_f32_bf16 v20, v86, v75
    v_dot2c_f32_bf16 v21, v86, v253
    v_dot2c_f32_bf16 v22, v87, v75
    v_dot2c_f32_bf16 v23, v87, v253
    v_dot2c_f32_bf16 v40, s16, v250
    v_dot2c_f32_bf16 v41, s16, v246
    v_dot2c_f32_bf16 v42, s16, v242
    v_dot2c_f32_bf16 v43, s16, v247
    v_dot2c_f32_bf16 v44, s16, v243
    v_dot2c_f32_bf16 v45, s16, v248
    v_dot2c_f32_bf16 v46, s16, v244
    v_dot2c_f32_bf16 v47, s16, v249
    v_dot2c_f32_bf16 v48, s16, v245
    v_dot2c_f32_bf16 v49, s16, v251
    v_dot2c_f32_bf16 v40, s17, v240
    v_dot2c_f32_bf16 v41, s17, v236
    v_dot2c_f32_bf16 v42, s17, v232
    v_dot2c_f32_bf16 v43, s17, v237
    v_dot2c_f32_bf16 v44, s17, v233
    v_dot2c_f32_bf16 v45, s17, v238
    v_dot2c_f32_bf16 v46, s17, v234
    v_dot2c_f32_bf16 v47, s17, v239
    v_dot2c_f32_bf16 v48, s17, v235
    s_waitcnt vmcnt(5)
    s_cmp_lt_u32 s38, 1
    s_cbranch_scc1 Lfb151
    s_waitcnt vmcnt(4)
    s_cmp_lt_u32 s38, 2
    s_cbranch_scc1 Lfb151
    s_waitcnt vmcnt(1)
Lfb151:
    buffer_load_dwordx4 v[104:107], v2, s[48:51], s10 offen offset:256 nt
    v_dot2c_f32_bf16 v24, v88, v75
    v_dot2c_f32_bf16 v25, v88, v253
    v_dot2c_f32_bf16 v26, v89, v75
    v_dot2c_f32_bf16 v27, v89, v253
    v_dot2c_f32_bf16 v28, v90, v75
    v_dot2c_f32_bf16 v29, v90, v253
    v_dot2c_f32_bf16 v30, v91, v75
    v_dot2c_f32_bf16 v31, v91, v253
    v_dot2c_f32_bf16 v49, s17, v241
    v_dot2c_f32_bf16 v40, s18, v230
    v_dot2c_f32_bf16 v41, s18, v226
    v_dot2c_f32_bf16 v42, s18, v222
    v_dot2c_f32_bf16 v43, s18, v227
    v_dot2c_f32_bf16 v44, s18, v223
    v_dot2c_f32_bf16 v45, s18, v228
    v_dot2c_f32_bf16 v46, s18, v224
    v_dot2c_f32_bf16 v47, s18, v229
    v_dot2c_f32_bf16 v48, s18, v225
    v_dot2c_f32_bf16 v49, s18, v231
    v_dot2c_f32_bf16 v40, s19, v220
    v_dot2c_f32_bf16 v41, s19, v216
    v_dot2c_f32_bf16 v42, s19, v212
    v_dot2c_f32_bf16 v43, s19, v217
    v_dot2c_f32_bf16 v44, s19, v213
    v_dot2c_f32_bf16 v45, s19, v218
    v_dot2c_f32_bf16 v46, s19, v214
    v_dot2c_f32_bf16 v47, s19, v219
    v_dot2c_f32_bf16 v48, s19, v215
    v_dot2c_f32_bf16 v49, s19, v221
    s_xor_b32 s80, s75, 57
    v_mov_b32 v9, s80
    s_mov_b64 exec, 1
    buffer_store_dword v9, v5, s[76:79], s39 offen
    s_mov_b64 exec, -1
    s_nop 0
    s_add_u32 s10, s9, 1769472
    s_cmp_ge_u32 s10, s8
    s_cselect_b32 s83, 3145728, 0
    s_sub_u32 s10, s10, s83
    s_add_u32 s10, s10, 100663296
    s_waitcnt vmcnt(6)
    s_cmp_lt_u32 s38, 1
    s_cbranch_scc1 Lfb152
    s_waitcnt vmcnt(3)
    s_cmp_lt_u32 s38, 2
    s_cbranch_scc1 Lfb152
    s_waitcnt vmcnt(2)
Lfb152:
    buffer_load_dwordx4 v[108:111], v2, s[48:51], s10 offen offset:0 nt
    v_dot2c_f32_bf16 v32, v92, v75
    v_dot2c_f32_bf16 v33, v92, v253
    v_dot2c_f32_bf16 v34, v93, v75
    v_dot2c_f32_bf16 v35, v93, v253
    v_dot2c_f32_bf16 v36, v94, v75
    v_dot2c_f32_bf16 v37, v94, v253
    v_dot2c_f32_bf16 v38, v95, v75
    v_dot2c_f32_bf16 v39, v95, v253
    ds_read_b32 v9, v11 offset:42304
    s_waitcnt lgkmcnt(0)
    v_add_f32_dpp v9, v9, v9 quad_perm:[1,0,3,2] row_mask:0xf bank_mask:0xf
    s_nop 1
    v_add_f32_dpp v9, v9, v9 quad_perm:[2,3,0,1] row_mask:0xf bank_mask:0xf
    s_nop 1
    v_add_f32_dpp v9, v9, v9 row_half_mirror row_mask:0xf bank_mask:0xf
    s_nop 1
    v_mov_b32_dpp v14, v9 row_ror:8 row_mask:0xf bank_mask:0xf
    v_cvt_pk_bf16_f32 v9, v9, v14
    s_nop 0
    v_readlane_b32 s16, v9, 0
    v_readlane_b32 s17, v9, 16
    v_readlane_b32 s18, v9, 32
    v_readlane_b32 s19, v9, 48
    s_waitcnt vmcnt(4)
    s_cmp_lt_u32 s38, 1
    s_cbranch_scc1 Lfb153
    s_waitcnt vmcnt(3)
    s_cmp_lt_u32 s38, 2
    s_cbranch_scc1 Lfb153
    s_waitcnt vmcnt(2)
Lfb153:
    buffer_load_dwordx4 v[112:115], v2, s[48:51], s10 offen offset:128 nt
    v_xor_b32 v9, s75, v254
    v_min_u32 v9, 64, v9
    s_and_b32 s80, s7, 31
    s_nop 1
    v_readlane_b32 s81, v9, s80
    s_nop 1
    v_cmp_gt_u32 vcc, s81, v9
    s_nop 1
    s_bcnt1_i32_b32 s82, vcc_lo
    v_cmp_lt_u32 vcc, s81, v9
    s_nop 1
    s_bcnt1_i32_b32 s83, vcc_lo
    s_sub_i32 s82, s82, s83
    v_cmp_eq_u32 vcc, 64, v9
    s_nop 1
    s_bcnt1_i32_b32 s83, vcc_lo
    s_add_i32 s82, s82, s83
    s_cmp_gt_i32 s82, 99
    s_cselect_b32 s38, 2, 1
    s_cmp_lt_i32 s82, -4
    s_cselect_b32 s38, 0, s38
    v_lshlrev_b32 v253, 16, v76
    v_dot2c_f32_bf16 v16, v96, v76
    v_dot2c_f32_bf16 v17, v96, v253
    v_dot2c_f32_bf16 v18, v97, v76
    v_dot2c_f32_bf16 v19, v97, v253
    v_dot2c_f32_bf16 v20, v98, v76
    v_dot2c_f32_bf16 v21, v98, v253
    v_dot2c_f32_bf16 v22, v99, v76
    v_dot2c_f32_bf16 v23, v99, v253
    v_dot2c_f32_bf16 v40, s16, v210
    v_dot2c_f32_bf16 v41, s16, v206
    v_dot2c_f32_bf16 v42, s16, v202
    v_dot2c_f32_bf16 v43, s16, v207
    v_dot2c_f32_bf16 v44, s16, v203
    v_dot2c_f32_bf16 v45, s16, v208
    v_dot2c_f32_bf16 v46, s16, v204
    v_dot2c_f32_bf16 v47, s16, v209
    v_dot2c_f32_bf16 v48, s16, v205
    v_dot2c_f32_bf16 v49, s16, v211
    v_dot2c_f32_bf16 v40, s17, v200
    v_dot2c_f32_bf16 v41, s17, v196
    v_dot2c_f32_bf16 v42, s17, v192
    v_dot2c_f32_bf16 v43, s17, v197
    v_dot2c_f32_bf16 v44, s17, v193
    v_dot2c_f32_bf16 v45, s17, v198
    v_dot2c_f32_bf16 v46, s17, v194
    v_dot2c_f32_bf16 v47, s17, v199
    v_dot2c_f32_bf16 v48, s17, v195
    s_waitcnt vmcnt(4)
    s_cmp_lt_u32 s38, 1
    s_cbranch_scc1 Lfb154
    s_waitcnt vmcnt(3)
    s_cmp_lt_u32 s38, 2
    s_cbranch_scc1 Lfb154
    s_waitcnt vmcnt(1)
Lfb154:
    buffer_load_dwordx4 v[116:119], v2, s[48:51], s10 offen offset:256 nt
    v_dot2c_f32_bf16 v24, v100, v76
    v_dot2c_f32_bf16 v25, v100, v253
    v_dot2c_f32_bf16 v26, v101, v76
    v_dot2c_f32_bf16 v27, v101, v253
    v_dot2c_f32_bf16 v28, v102, v76
    v_dot2c_f32_bf16 v29, v102, v253
    v_dot2c_f32_bf16 v30, v103, v76
    v_dot2c_f32_bf16 v31, v103, v253
    v_dot2c_f32_bf16 v49, s17, v201
    v_dot2c_f32_bf16 v40, s18, v190
    v_dot2c_f32_bf16 v41, s18, v186
    v_dot2c_f32_bf16 v42, s18, v182
    v_dot2c_f32_bf16 v43, s18, v187
    v_dot2c_f32_bf16 v44, s18, v183
    v_dot2c_f32_bf16 v45, s18, v188
    v_dot2c_f32_bf16 v46, s18, v184
    v_dot2c_f32_bf16 v47, s18, v189
    v_dot2c_f32_bf16 v48, s18, v185
    v_dot2c_f32_bf16 v49, s18, v191
    v_dot2c_f32_bf16 v40, s19, v180
    v_dot2c_f32_bf16 v41, s19, v176
    v_dot2c_f32_bf16 v42, s19, v172
    v_dot2c_f32_bf16 v43, s19, v177
    v_dot2c_f32_bf16 v44, s19, v173
    v_dot2c_f32_bf16 v45, s19, v178
    v_dot2c_f32_bf16 v46, s19, v174
    v_dot2c_f32_bf16 v47, s19, v179
    v_dot2c_f32_bf16 v48, s19, v175
    v_dot2c_f32_bf16 v49, s19, v181
    s_barrier
    s_xor_b32 s80, s75, 58
    v_mov_b32 v9, s80
    s_mov_b64 exec, 1
    buffer_store_dword v9, v5, s[76:79], s39 offen
    s_lshr_b32 s80, s7, 5
    s_lshl_b32 s80, s80, 8
    s_add_u32 s80, s80, 40960
    s_mov_b32 exec_lo, -1
    buffer_load_dword v254, v5, s[76:79], s80 offen sc1
    s_mov_b64 exec, -1
    s_nop 0
    s_add_u32 s10, s9, 1966080
    s_cmp_ge_u32 s10, s8
    s_cselect_b32 s83, 3145728, 0
    s_sub_u32 s10, s10, s83
    s_add_u32 s10, s10, 100663296
    s_waitcnt vmcnt(6)
    s_cmp_lt_u32 s38, 1
    s_cbranch_scc1 Lfb155
    s_waitcnt vmcnt(4)
    s_cmp_lt_u32 s38, 2
    s_cbranch_scc1 Lfb155
    s_waitcnt vmcnt(3)
Lfb155:
    buffer_load_dwordx4 v[84:87], v2, s[48:51], s10 offen offset:0 nt
    v_dot2c_f32_bf16 v32, v104, v76
    v_dot2c_f32_bf16 v33, v104, v253
    v_dot2c_f32_bf16 v34, v105, v76
    v_dot2c_f32_bf16 v35, v105, v253
    v_dot2c_f32_bf16 v36, v106, v76
    v_dot2c_f32_bf16 v37, v106, v253
    v_dot2c_f32_bf16 v38, v107, v76
    v_dot2c_f32_bf16 v39, v107, v253
    ds_read_b32 v9, v11 offset:42560
    s_waitcnt lgkmcnt(0)
    v_add_f32_dpp v9, v9, v9 quad_perm:[1,0,3,2] row_mask:0xf bank_mask:0xf
    s_nop 1
    v_add_f32_dpp v9, v9, v9 quad_perm:[2,3,0,1] row_mask:0xf bank_mask:0xf
    s_nop 1
    v_add_f32_dpp v9, v9, v9 row_half_mirror row_mask:0xf bank_mask:0xf
    s_nop 1
    v_mov_b32_dpp v14, v9 row_ror:8 row_mask:0xf bank_mask:0xf
    v_cvt_pk_bf16_f32 v9, v9, v14
    s_nop 0
    v_readlane_b32 s16, v9, 0
    v_readlane_b32 s17, v9, 16
    v_readlane_b32 s18, v9, 32
    v_readlane_b32 s19, v9, 48
    s_waitcnt vmcnt(5)
    s_cmp_lt_u32 s38, 1
    s_cbranch_scc1 Lfb156
    s_waitcnt vmcnt(4)
    s_cmp_lt_u32 s38, 2
    s_cbranch_scc1 Lfb156
    s_waitcnt vmcnt(3)
Lfb156:
    buffer_load_dwordx4 v[88:91], v2, s[48:51], s10 offen offset:128 nt
    v_lshlrev_b32 v253, 16, v77
    v_dot2c_f32_bf16 v16, v108, v77
    v_dot2c_f32_bf16 v17, v108, v253
    v_dot2c_f32_bf16 v18, v109, v77
    v_dot2c_f32_bf16 v19, v109, v253
    v_dot2c_f32_bf16 v20, v110, v77
    v_dot2c_f32_bf16 v21, v110, v253
    v_dot2c_f32_bf16 v22, v111, v77
    v_dot2c_f32_bf16 v23, v111, v253
    v_dot2c_f32_bf16 v40, s16, v170
    v_dot2c_f32_bf16 v41, s16, v166
    v_dot2c_f32_bf16 v42, s16, v162
    v_dot2c_f32_bf16 v43, s16, v167
    v_dot2c_f32_bf16 v44, s16, v163
    v_dot2c_f32_bf16 v45, s16, v168
    v_dot2c_f32_bf16 v46, s16, v164
    v_dot2c_f32_bf16 v47, s16, v169
    v_dot2c_f32_bf16 v48, s16, v165
    v_dot2c_f32_bf16 v49, s16, v171
    v_dot2c_f32_bf16 v40, s17, v160
    v_dot2c_f32_bf16 v41, s17, v156
    v_dot2c_f32_bf16 v42, s17, v152
    v_dot2c_f32_bf16 v43, s17, v157
    v_dot2c_f32_bf16 v44, s17, v153
    v_dot2c_f32_bf16 v45, s17, v158
    v_dot2c_f32_bf16 v46, s17, v154
    v_dot2c_f32_bf16 v47, s17, v159
    v_dot2c_f32_bf16 v48, s17, v155
    s_waitcnt vmcnt(5)
    s_cmp_lt_u32 s38, 1
    s_cbranch_scc1 Lfb157
    s_waitcnt vmcnt(4)
    s_cmp_lt_u32 s38, 2
    s_cbranch_scc1 Lfb157
    s_waitcnt vmcnt(1)
Lfb157:
    buffer_load_dwordx4 v[92:95], v2, s[48:51], s10 offen offset:256 nt
    v_dot2c_f32_bf16 v24, v112, v77
    v_dot2c_f32_bf16 v25, v112, v253
    v_dot2c_f32_bf16 v26, v113, v77
    v_dot2c_f32_bf16 v27, v113, v253
    v_dot2c_f32_bf16 v28, v114, v77
    v_dot2c_f32_bf16 v29, v114, v253
    v_dot2c_f32_bf16 v30, v115, v77
    v_dot2c_f32_bf16 v31, v115, v253
    v_dot2c_f32_bf16 v49, s17, v161
    v_dot2c_f32_bf16 v40, s18, v150
    v_dot2c_f32_bf16 v41, s18, v146
    v_dot2c_f32_bf16 v42, s18, v142
    v_dot2c_f32_bf16 v43, s18, v147
    v_dot2c_f32_bf16 v44, s18, v143
    v_dot2c_f32_bf16 v45, s18, v148
    v_dot2c_f32_bf16 v46, s18, v144
    v_dot2c_f32_bf16 v47, s18, v149
    v_dot2c_f32_bf16 v48, s18, v145
    v_dot2c_f32_bf16 v49, s18, v151
    v_dot2c_f32_bf16 v40, s19, v140
    v_dot2c_f32_bf16 v41, s19, v136
    v_dot2c_f32_bf16 v42, s19, v132
    v_dot2c_f32_bf16 v43, s19, v137
    v_dot2c_f32_bf16 v44, s19, v133
    v_dot2c_f32_bf16 v45, s19, v138
    v_dot2c_f32_bf16 v46, s19, v134
    v_dot2c_f32_bf16 v47, s19, v139
    v_dot2c_f32_bf16 v48, s19, v135
    v_dot2c_f32_bf16 v49, s19, v141
    s_xor_b32 s80, s75, 59
    v_mov_b32 v9, s80
    s_mov_b64 exec, 1
    buffer_store_dword v9, v5, s[76:79], s39 offen
    s_mov_b64 exec, -1
    s_nop 0
    s_add_u32 s10, s9, 2162688
    s_cmp_ge_u32 s10, s8
    s_cselect_b32 s83, 3145728, 0
    s_sub_u32 s10, s10, s83
    s_add_u32 s10, s10, 100663296
    s_waitcnt vmcnt(6)
    s_cmp_lt_u32 s38, 1
    s_cbranch_scc1 Lfb158
    s_waitcnt vmcnt(3)
    s_cmp_lt_u32 s38, 2
    s_cbranch_scc1 Lfb158
    s_waitcnt vmcnt(2)
Lfb158:
    buffer_load_dwordx4 v[96:99], v2, s[48:51], s10 offen offset:0 nt
    v_dot2c_f32_bf16 v32, v116, v77
    v_dot2c_f32_bf16 v33, v116, v253
    v_dot2c_f32_bf16 v34, v117, v77
    v_dot2c_f32_bf16 v35, v117, v253
    v_dot2c_f32_bf16 v36, v118, v77
    v_dot2c_f32_bf16 v37, v118, v253
    v_dot2c_f32_bf16 v38, v119, v77
    v_dot2c_f32_bf16 v39, v119, v253
    ds_write_b128 v12, v[40:43] offset:0
    ds_write_b128 v12, v[44:47] offset:16
    ds_write_b64 v6, v[48:49] offset:2048
    s_waitcnt vmcnt(4)
    s_cmp_lt_u32 s38, 1
    s_cbranch_scc1 Lfb159
    s_waitcnt vmcnt(3)
    s_cmp_lt_u32 s38, 2
    s_cbranch_scc1 Lfb159
    s_waitcnt vmcnt(2)
Lfb159:
    buffer_load_dwordx4 v[100:103], v2, s[48:51], s10 offen offset:128 nt
    v_xor_b32 v9, s75, v254
    v_min_u32 v9, 64, v9
    s_and_b32 s80, s7, 31
    s_nop 1
    v_readlane_b32 s81, v9, s80
    s_nop 1
    v_cmp_gt_u32 vcc, s81, v9
    s_nop 1
    s_bcnt1_i32_b32 s82, vcc_lo
    v_cmp_lt_u32 vcc, s81, v9
    s_nop 1
    s_bcnt1_i32_b32 s83, vcc_lo
    s_sub_i32 s82, s82, s83
    v_cmp_eq_u32 vcc, 64, v9
    s_nop 1
    s_bcnt1_i32_b32 s83, vcc_lo
    s_add_i32 s82, s82, s83
    s_cmp_gt_i32 s82, 99
    s_cselect_b32 s38, 2, 1
    s_cmp_lt_i32 s82, -4
    s_cselect_b32 s38, 0, s38
    v_lshlrev_b32 v253, 16, v78
    v_dot2c_f32_bf16 v16, v84, v78
    v_dot2c_f32_bf16 v17, v84, v253
    v_dot2c_f32_bf16 v18, v85, v78
    v_dot2c_f32_bf16 v19, v85, v253
    v_dot2c_f32_bf16 v20, v86, v78
    v_dot2c_f32_bf16 v21, v86, v253
    v_dot2c_f32_bf16 v22, v87, v78
    v_dot2c_f32_bf16 v23, v87, v253
    s_waitcnt vmcnt(4)
    s_cmp_lt_u32 s38, 1
    s_cbranch_scc1 Lfb160
    s_waitcnt vmcnt(3)
    s_cmp_lt_u32 s38, 2
    s_cbranch_scc1 Lfb160
    s_waitcnt vmcnt(1)
Lfb160:
    buffer_load_dwordx4 v[104:107], v2, s[48:51], s10 offen offset:256 nt
    v_dot2c_f32_bf16 v24, v88, v78
    v_dot2c_f32_bf16 v25, v88, v253
    v_dot2c_f32_bf16 v26, v89, v78
    v_dot2c_f32_bf16 v27, v89, v253
    v_dot2c_f32_bf16 v28, v90, v78
    v_dot2c_f32_bf16 v29, v90, v253
    v_dot2c_f32_bf16 v30, v91, v78
    v_dot2c_f32_bf16 v31, v91, v253
    s_waitcnt lgkmcnt(0)
    s_barrier
    s_xor_b32 s80, s75, 60
    v_mov_b32 v9, s80
    s_mov_b64 exec, 1
    buffer_store_dword v9, v5, s[76:79], s39 offen
    s_lshr_b32 s80, s7, 5
    s_lshl_b32 s80, s80, 8
    s_add_u32 s80, s80, 40960
    s_mov_b32 exec_lo, -1
    buffer_load_dword v254, v5, s[76:79], s80 offen sc1
    s_mov_b64 exec, -1
    s_nop 0
    s_add_u32 s10, s9, 2359296
    s_cmp_ge_u32 s10, s8
    s_cselect_b32 s83, 3145728, 0
    s_sub_u32 s10, s10, s83
    s_add_u32 s10, s10, 100663296
    s_waitcnt vmcnt(6)
    s_cmp_lt_u32 s38, 1
    s_cbranch_scc1 Lfb161
    s_waitcnt vmcnt(4)
    s_cmp_lt_u32 s38, 2
    s_cbranch_scc1 Lfb161
    s_waitcnt vmcnt(3)
Lfb161:
    buffer_load_dwordx4 v[108:111], v2, s[48:51], s10 offen offset:0 nt
    v_dot2c_f32_bf16 v32, v92, v78
    v_dot2c_f32_bf16 v33, v92, v253
    v_dot2c_f32_bf16 v34, v93, v78
    v_dot2c_f32_bf16 v35, v93, v253
    v_dot2c_f32_bf16 v36, v94, v78
    v_dot2c_f32_bf16 v37, v94, v253
    v_dot2c_f32_bf16 v38, v95, v78
    v_dot2c_f32_bf16 v39, v95, v253
    s_andn2_b32 s81, s7, 7
    s_mul_i32 s81, s81, 5120
    s_mul_i32 s80, s6, 320
    s_add_u32 s81, s81, s80
    s_add_u32 s81, s81, 327680
    s_cmp_eq_u32 s3, 3
    s_cselect_b32 s26, s81, 1073741824
    s_cbranch_scc0 Ly0
    v_lshrrev_b32 v9, 5, v1
    v_mul_u32_u24 v9, 19968, v9
    v_add3_u32 v9, v9, s80, v4
    ds_read_b128 v[40:43], v9 offset:0
    ds_read_b128 v[44:47], v9 offset:5120
    ds_read_b128 v[48:51], v9 offset:10240
    ds_read_b128 v[64:67], v9 offset:15360
    s_waitcnt lgkmcnt(2)
    v_pk_add_f32 v[40:41], v[40:41], v[44:45]
    v_pk_add_f32 v[42:43], v[42:43], v[46:47]
    s_waitcnt lgkmcnt(1)
    v_pk_add_f32 v[40:41], v[40:41], v[48:49]
    v_pk_add_f32 v[42:43], v[42:43], v[50:51]
    s_waitcnt lgkmcnt(0)
    v_pk_add_f32 v[40:41], v[40:41], v[64:65]
    v_pk_add_f32 v[42:43], v[42:43], v[66:67]
    v_mov_b64 v[44:45], v[40:41]
    v_mov_b64 v[46:47], v[42:43]
    s_nop 0
    v_permlane32_swap_b32 v40, v44
    v_permlane32_swap_b32 v41, v45
    v_permlane32_swap_b32 v42, v46
    v_permlane32_swap_b32 v43, v47
    v_pk_add_f32 v[40:41], v[40:41], v[44:45]
    v_pk_add_f32 v[42:43], v[42:43], v[46:47]
    v_mov_b32_sdwa v40, s75 dst_sel:BYTE_0 dst_unused:UNUSED_PRESERVE src0_sel:BYTE_0
    v_mov_b32_sdwa v41, s75 dst_sel:BYTE_0 dst_unused:UNUSED_PRESERVE src0_sel:BYTE_1
    v_mov_b32_sdwa v42, s75 dst_sel:BYTE_0 dst_unused:UNUSED_PRESERVE src0_sel:BYTE_2
    v_mov_b32_sdwa v43, s75 dst_sel:BYTE_0 dst_unused:UNUSED_PRESERVE src0_sel:BYTE_3
    s_nop 0
Ly0:
    s_waitcnt vmcnt(5)
    s_cmp_lt_u32 s38, 1
    s_cbranch_scc1 Lfb162
    s_waitcnt vmcnt(4)
    s_cmp_lt_u32 s38, 2
    s_cbranch_scc1 Lfb162
    s_waitcnt vmcnt(3)
Lfb162:
    buffer_load_dwordx4 v[112:115], v2, s[48:51], s10 offen offset:128 nt
    v_lshlrev_b32 v253, 16, v79
    v_dot2c_f32_bf16 v16, v96, v79
    v_dot2c_f32_bf16 v17, v96, v253
    v_dot2c_f32_bf16 v18, v97, v79
    v_dot2c_f32_bf16 v19, v97, v253
    v_dot2c_f32_bf16 v20, v98, v79
    v_dot2c_f32_bf16 v21, v98, v253
    v_dot2c_f32_bf16 v22, v99, v79
    v_dot2c_f32_bf16 v23, v99, v253
    s_waitcnt vmcnt(5)
    s_cmp_lt_u32 s38, 1
    s_cbranch_scc1 Lfb163
    s_waitcnt vmcnt(4)
    s_cmp_lt_u32 s38, 2
    s_cbranch_scc1 Lfb163
    s_waitcnt vmcnt(1)
Lfb163:
    buffer_load_dwordx4 v[116:119], v2, s[48:51], s10 offen offset:256 nt
    v_dot2c_f32_bf16 v24, v100, v79
    v_dot2c_f32_bf16 v25, v100, v253
    v_dot2c_f32_bf16 v26, v101, v79
    v_dot2c_f32_bf16 v27, v101, v253
    v_dot2c_f32_bf16 v28, v102, v79
    v_dot2c_f32_bf16 v29, v102, v253
    v_dot2c_f32_bf16 v30, v103, v79
    v_dot2c_f32_bf16 v31, v103, v253
    s_add_u32 s10, s9, 2555904
    s_cmp_ge_u32 s10, s8
    s_cselect_b32 s83, 3145728, 0
    s_sub_u32 s10, s10, s83
    s_add_u32 s10, s10, 100663296
    s_waitcnt vmcnt(5)
    s_cmp_lt_u32 s38, 1
    s_cbranch_scc1 Lfb164
    s_waitcnt vmcnt(2)
    s_cmp_lt_u32 s38, 2
    s_cbranch_scc1 Lfb164
    s_waitcnt vmcnt(1)
Lfb164:
    buffer_load_dwordx4 v[84:87], v2, s[48:51], s10 offen offset:0 nt
    v_dot2c_f32_bf16 v32, v104, v79
    v_dot2c_f32_bf16 v33, v104, v253
    v_dot2c_f32_bf16 v34, v105, v79
    v_dot2c_f32_bf16 v35, v105, v253
    v_dot2c_f32_bf16 v36, v106, v79
    v_dot2c_f32_bf16 v37, v106, v253
    v_dot2c_f32_bf16 v38, v107, v79
    v_dot2c_f32_bf16 v39, v107, v253
    s_add_u32 s10, s9, 2752512
    s_cmp_ge_u32 s10, s8
    s_cselect_b32 s83, 3145728, 0
    s_sub_u32 s10, s10, s83
    s_add_u32 s10, s10, 100663296
    s_waitcnt vmcnt(3)
    s_cmp_lt_u32 s38, 1
    s_cbranch_scc1 Lfb165
    s_waitcnt vmcnt(2)
    s_cmp_lt_u32 s38, 2
    s_cbranch_scc1 Lfb165
    s_waitcnt vmcnt(1)
Lfb165:
    buffer_load_dwordx4 v[88:91], v2, s[48:51], s10 offen offset:0 nt
    v_xor_b32 v9, s75, v254
    v_min_u32 v9, 64, v9
    s_and_b32 s80, s7, 31
    s_nop 1
    v_readlane_b32 s81, v9, s80
    s_nop 1
    v_cmp_gt_u32 vcc, s81, v9
    s_nop 1
    s_bcnt1_i32_b32 s82, vcc_lo
    v_cmp_lt_u32 vcc, s81, v9
    s_nop 1
    s_bcnt1_i32_b32 s83, vcc_lo
    s_sub_i32 s82, s82, s83
    v_cmp_eq_u32 vcc, 64, v9
    s_nop 1
    s_bcnt1_i32_b32 s83, vcc_lo
    s_add_i32 s82, s82, s83
    s_cmp_gt_i32 s82, 99
    s_cselect_b32 s38, 2, 1
    s_cmp_lt_i32 s82, -4
    s_cselect_b32 s38, 0, s38
    v_lshlrev_b32 v253, 16, v80
    v_dot2c_f32_bf16 v16, v108, v80
    v_dot2c_f32_bf16 v17, v108, v253
    v_dot2c_f32_bf16 v18, v109, v80
    v_dot2c_f32_bf16 v19, v109, v253
    v_dot2c_f32_bf16 v20, v110, v80
    v_dot2c_f32_bf16 v21, v110, v253
    v_dot2c_f32_bf16 v22, v111, v80
    v_dot2c_f32_bf16 v23, v111, v253
    s_add_u32 s10, s9, 2949120
    s_cmp_ge_u32 s10, s8
    s_cselect_b32 s83, 3145728, 0
    s_sub_u32 s10, s10, s83
    s_add_u32 s10, s10, 100663296
    s_waitcnt vmcnt(3)
    s_cmp_lt_u32 s38, 1
    s_cbranch_scc1 Lfb166
    s_waitcnt vmcnt(2)
    s_cmp_lt_u32 s38, 2
    s_cbranch_scc1 Lfb166
    s_waitcnt vmcnt(1)
Lfb166:
    buffer_load_dwordx4 v[92:95], v2, s[48:51], s10 offen offset:0 nt
    v_dot2c_f32_bf16 v24, v112, v80
    v_dot2c_f32_bf16 v25, v112, v253
    v_dot2c_f32_bf16 v26, v113, v80
    v_dot2c_f32_bf16 v27, v113, v253
    v_dot2c_f32_bf16 v28, v114, v80
    v_dot2c_f32_bf16 v29, v114, v253
    v_dot2c_f32_bf16 v30, v115, v80
    v_dot2c_f32_bf16 v31, v115, v253
    s_barrier
    s_add_u32 s10, s9, 2555904
    s_cmp_ge_u32 s10, s8
    s_cselect_b32 s83, 3145728, 0
    s_sub_u32 s10, s10, s83
    s_add_u32 s10, s10, 100663296
    s_waitcnt vmcnt(2)
    s_cmp_lt_u32 s38, 2
    s_cbranch_scc1 Lfb167
    s_waitcnt vmcnt(1)
Lfb167:
    buffer_load_dwordx4 v[96:99], v2, s[48:51], s10 offen offset:128 nt
    v_dot2c_f32_bf16 v32, v116, v80
    v_dot2c_f32_bf16 v33, v116, v253
    v_dot2c_f32_bf16 v34, v117, v80
    v_dot2c_f32_bf16 v35, v117, v253
    v_dot2c_f32_bf16 v36, v118, v80
    v_dot2c_f32_bf16 v37, v118, v253
    v_dot2c_f32_bf16 v38, v119, v80
    v_dot2c_f32_bf16 v39, v119, v253
    v_lshlrev_b32 v68, 16, v81
    v_dot2c_f32_bf16 v16, v84, v81
    v_dot2c_f32_bf16 v17, v84, v68
    v_dot2c_f32_bf16 v18, v85, v81
    v_dot2c_f32_bf16 v19, v85, v68
    v_dot2c_f32_bf16 v20, v86, v81
    v_dot2c_f32_bf16 v21, v86, v68
    v_dot2c_f32_bf16 v22, v87, v81
    v_dot2c_f32_bf16 v23, v87, v68
    s_add_u32 s10, s9, 2752512
    s_cmp_ge_u32 s10, s8
    s_cselect_b32 s83, 3145728, 0
    s_sub_u32 s10, s10, s83
    s_add_u32 s10, s10, 100663296
    s_waitcnt vmcnt(2)
    s_cmp_lt_u32 s38, 2
    s_cbranch_scc1 Lfb168
    s_waitcnt vmcnt(1)
Lfb168:
    buffer_load_dwordx4 v[100:103], v2, s[48:51], s10 offen offset:128 nt
    v_lshlrev_b32 v69, 16, v82
    v_dot2c_f32_bf16 v16, v88, v82
    v_dot2c_f32_bf16 v17, v88, v69
    v_dot2c_f32_bf16 v18, v89, v82
    v_dot2c_f32_bf16 v19, v89, v69
    v_dot2c_f32_bf16 v20, v90, v82
    v_dot2c_f32_bf16 v21, v90, v69
    v_dot2c_f32_bf16 v22, v91, v82
    v_dot2c_f32_bf16 v23, v91, v69
    s_add_u32 s10, s9, 2949120
    s_cmp_ge_u32 s10, s8
    s_cselect_b32 s83, 3145728, 0
    s_sub_u32 s10, s10, s83
    s_add_u32 s10, s10, 100663296
    s_waitcnt vmcnt(2)
    s_cmp_lt_u32 s38, 2
    s_cbranch_scc1 Lfb169
    s_waitcnt vmcnt(1)
Lfb169:
    buffer_load_dwordx4 v[104:107], v2, s[48:51], s10 offen offset:128 nt
    v_lshlrev_b32 v70, 16, v83
    v_dot2c_f32_bf16 v16, v92, v83
    v_dot2c_f32_bf16 v17, v92, v70
    v_dot2c_f32_bf16 v18, v93, v83
    v_dot2c_f32_bf16 v19, v93, v70
    v_dot2c_f32_bf16 v20, v94, v83
    v_dot2c_f32_bf16 v21, v94, v70
    v_dot2c_f32_bf16 v22, v95, v83
    v_dot2c_f32_bf16 v23, v95, v70
    v_permlane32_swap_b32 v16, v20
    v_permlane32_swap_b32 v17, v21
    v_permlane32_swap_b32 v18, v22
    v_permlane32_swap_b32 v19, v23
    v_pk_add_f32 v[16:17], v[16:17], v[20:21]
    v_pk_add_f32 v[18:19], v[18:19], v[22:23]
    s_nop 1
    v_permlane16_swap_b32 v16, v18
    v_permlane16_swap_b32 v17, v19
    v_pk_add_f32 v[16:17], v[16:17], v[18:19]
    s_nop 1
    v_add_f32_dpp v18, v16, v16 row_ror:8 row_mask:0xf bank_mask:0x3
    s_nop 1
    v_add_f32_dpp v18, v17, v17 row_ror:8 row_mask:0xf bank_mask:0xc
    v_mul_f32 v9, s29, v18
    ds_write_b32 v10, v9 offset:48448
    s_waitcnt lgkmcnt(0)
    s_barrier
    s_add_u32 s10, s9, 2555904
    s_cmp_ge_u32 s10, s8
    s_cselect_b32 s83, 3145728, 0
    s_sub_u32 s10, s10, s83
    s_add_u32 s10, s10, 100663296
    s_waitcnt vmcnt(2)
    s_cmp_lt_u32 s38, 2
    s_cbranch_scc1 Lfb170
    s_waitcnt vmcnt(1)
Lfb170:
    buffer_load_dwordx4 v[84:87], v2, s[48:51], s10 offen offset:256 nt
    v_dot2c_f32_bf16 v24, v96, v81
    v_dot2c_f32_bf16 v25, v96, v68
    v_dot2c_f32_bf16 v26, v97, v81
    v_dot2c_f32_bf16 v27, v97, v68
    v_dot2c_f32_bf16 v28, v98, v81
    v_dot2c_f32_bf16 v29, v98, v68
    v_dot2c_f32_bf16 v30, v99, v81
    v_dot2c_f32_bf16 v31, v99, v68
    ds_read_b32 v9, v11 offset:48448
    s_waitcnt lgkmcnt(0)
    v_add_f32_dpp v9, v9, v9 quad_perm:[1,0,3,2] row_mask:0xf bank_mask:0xf
    s_nop 1
    v_add_f32_dpp v9, v9, v9 quad_perm:[2,3,0,1] row_mask:0xf bank_mask:0xf
    s_nop 1
    v_add_f32_dpp v9, v9, v9 row_half_mirror row_mask:0xf bank_mask:0xf
    s_nop 1
    v_mov_b32_dpp v14, v9 row_ror:8 row_mask:0xf bank_mask:0xf
    v_cvt_pk_bf16_f32 v9, v9, v14
    s_nop 0
    v_readlane_b32 s16, v9, 0
    v_readlane_b32 s17, v9, 16
    v_readlane_b32 s18, v9, 32
    v_readlane_b32 s19, v9, 48
    s_add_u32 s10, s9, 2752512
    s_cmp_ge_u32 s10, s8
    s_cselect_b32 s83, 3145728, 0
    s_sub_u32 s10, s10, s83
    s_add_u32 s10, s10, 100663296
    s_waitcnt vmcnt(2)
    s_cmp_lt_u32 s38, 2
    s_cbranch_scc1 Lfb171
    s_waitcnt vmcnt(1)
Lfb171:
    buffer_load_dwordx4 v[88:91], v2, s[48:51], s10 offen offset:256 nt
    v_dot2c_f32_bf16 v24, v100, v82
    v_dot2c_f32_bf16 v25, v100, v69
    v_dot2c_f32_bf16 v26, v101, v82
    v_dot2c_f32_bf16 v27, v101, v69
    v_dot2c_f32_bf16 v28, v102, v82
    v_dot2c_f32_bf16 v29, v102, v69
    v_dot2c_f32_bf16 v30, v103, v82
    v_dot2c_f32_bf16 v31, v103, v69
    v_dot2c_f32_bf16 v52, s16, v250
    v_dot2c_f32_bf16 v53, s16, v246
    v_dot2c_f32_bf16 v54, s16, v242
    v_dot2c_f32_bf16 v55, s16, v247
    v_dot2c_f32_bf16 v56, s16, v243
    v_dot2c_f32_bf16 v57, s16, v248
    v_dot2c_f32_bf16 v58, s16, v244
    v_dot2c_f32_bf16 v59, s16, v249
    v_dot2c_f32_bf16 v60, s16, v245
    v_dot2c_f32_bf16 v61, s16, v251
    v_dot2c_f32_bf16 v52, s17, v240
    v_dot2c_f32_bf16 v53, s17, v236
    v_dot2c_f32_bf16 v54, s17, v232
    v_dot2c_f32_bf16 v55, s17, v237
    v_dot2c_f32_bf16 v56, s17, v233
    v_dot2c_f32_bf16 v57, s17, v238
    v_dot2c_f32_bf16 v58, s17, v234
    v_dot2c_f32_bf16 v59, s17, v239
    v_dot2c_f32_bf16 v60, s17, v235
    s_add_u32 s10, s9, 2949120
    s_cmp_ge_u32 s10, s8
    s_cselect_b32 s83, 3145728, 0
    s_sub_u32 s10, s10, s83
    s_add_u32 s10, s10, 100663296
    s_waitcnt vmcnt(2)
    s_cmp_lt_u32 s38, 2
    s_cbranch_scc1 Lfb172
    s_waitcnt vmcnt(1)
Lfb172:
    buffer_load_dwordx4 v[92:95], v2, s[48:51], s10 offen offset:256 nt
    v_dot2c_f32_bf16 v24, v104, v83
    v_dot2c_f32_bf16 v25, v104, v70
    v_dot2c_f32_bf16 v26, v105, v83
    v_dot2c_f32_bf16 v27, v105, v70
    v_dot2c_f32_bf16 v28, v106, v83
    v_dot2c_f32_bf16 v29, v106, v70
    v_dot2c_f32_bf16 v30, v107, v83
    v_dot2c_f32_bf16 v31, v107, v70
    v_permlane32_swap_b32 v24, v28
    v_permlane32_swap_b32 v25, v29
    v_permlane32_swap_b32 v26, v30
    v_permlane32_swap_b32 v27, v31
    v_pk_add_f32 v[24:25], v[24:25], v[28:29]
    v_pk_add_f32 v[26:27], v[26:27], v[30:31]
    s_nop 1
    v_permlane16_swap_b32 v24, v26
    v_permlane16_swap_b32 v25, v27
    v_pk_add_f32 v[24:25], v[24:25], v[26:27]
    s_nop 1
    v_add_f32_dpp v26, v24, v24 row_ror:8 row_mask:0xf bank_mask:0x3
    s_nop 1
    v_add_f32_dpp v26, v25, v25 row_ror:8 row_mask:0xf bank_mask:0xc
    v_mul_f32 v9, s29, v26
    ds_write_b32 v10, v9 offset:48704
    v_dot2c_f32_bf16 v61, s17, v241
    v_dot2c_f32_bf16 v52, s18, v230
    v_dot2c_f32_bf16 v53, s18, v226
    v_dot2c_f32_bf16 v54, s18, v222
    v_dot2c_f32_bf16 v55, s18, v227
    v_dot2c_f32_bf16 v56, s18, v223
    v_dot2c_f32_bf16 v57, s18, v228
    v_dot2c_f32_bf16 v58, s18, v224
    v_dot2c_f32_bf16 v59, s18, v229
    v_dot2c_f32_bf16 v60, s18, v225
    v_dot2c_f32_bf16 v61, s18, v231
    v_dot2c_f32_bf16 v52, s19, v220
    v_dot2c_f32_bf16 v53, s19, v216
    v_dot2c_f32_bf16 v54, s19, v212
    v_dot2c_f32_bf16 v55, s19, v217
    v_dot2c_f32_bf16 v56, s19, v213
    v_dot2c_f32_bf16 v57, s19, v218
    v_dot2c_f32_bf16 v58, s19, v214
    v_dot2c_f32_bf16 v59, s19, v219
    v_dot2c_f32_bf16 v60, s19, v215
    v_dot2c_f32_bf16 v61, s19, v221
    s_waitcnt lgkmcnt(0)
    s_barrier
    s_mov_b32 s101, 200000
    s_mov_b64 exec, 0xfffff
    buffer_store_dwordx4 v[40:43], v4, s[76:79], s26 offen sc1
    s_mov_b64 exec, -1
    ds_read_b32 v9, v11 offset:48704
    s_waitcnt lgkmcnt(0)
    v_add_f32_dpp v9, v9, v9 quad_perm:[1,0,3,2] row_mask:0xf bank_mask:0xf
    s_nop 1
    v_add_f32_dpp v9, v9, v9 quad_perm:[2,3,0,1] row_mask:0xf bank_mask:0xf
    s_nop 1
    v_add_f32_dpp v9, v9, v9 row_half_mirror row_mask:0xf bank_mask:0xf
    s_nop 1
    v_mov_b32_dpp v14, v9 row_ror:8 row_mask:0xf bank_mask:0xf
    v_cvt_pk_bf16_f32 v9, v9, v14
    s_nop 0
    v_readlane_b32 s16, v9, 0
    v_readlane_b32 s17, v9, 16
    v_readlane_b32 s18, v9, 32
    v_readlane_b32 s19, v9, 48
    s_waitcnt vmcnt(3)
    v_dot2c_f32_bf16 v32, v84, v81
    v_dot2c_f32_bf16 v33, v84, v68
    v_dot2c_f32_bf16 v34, v85, v81
    v_dot2c_f32_bf16 v35, v85, v68
    v_dot2c_f32_bf16 v36, v86, v81
    v_dot2c_f32_bf16 v37, v86, v68
    v_dot2c_f32_bf16 v38, v87, v81
    v_dot2c_f32_bf16 v39, v87, v68
    v_dot2c_f32_bf16 v52, s16, v210
    v_dot2c_f32_bf16 v53, s16, v206
    v_dot2c_f32_bf16 v54, s16, v202
    v_dot2c_f32_bf16 v55, s16, v207
    v_dot2c_f32_bf16 v56, s16, v203
    v_dot2c_f32_bf16 v57, s16, v208
    v_dot2c_f32_bf16 v58, s16, v204
    v_dot2c_f32_bf16 v59, s16, v209
    v_dot2c_f32_bf16 v60, s16, v205
    v_dot2c_f32_bf16 v61, s16, v211
    v_dot2c_f32_bf16 v52, s17, v200
    v_dot2c_f32_bf16 v53, s17, v196
    v_dot2c_f32_bf16 v54, s17, v192
    v_dot2c_f32_bf16 v55, s17, v197
    v_dot2c_f32_bf16 v56, s17, v193
    v_dot2c_f32_bf16 v57, s17, v198
    v_dot2c_f32_bf16 v58, s17, v194
    v_dot2c_f32_bf16 v59, s17, v199
    v_dot2c_f32_bf16 v60, s17, v195
    s_waitcnt vmcnt(2)
    v_dot2c_f32_bf16 v32, v88, v82
    v_dot2c_f32_bf16 v33, v88, v69
    v_dot2c_f32_bf16 v34, v89, v82
    v_dot2c_f32_bf16 v35, v89, v69
    v_dot2c_f32_bf16 v36, v90, v82
    v_dot2c_f32_bf16 v37, v90, v69
    v_dot2c_f32_bf16 v38, v91, v82
    v_dot2c_f32_bf16 v39, v91, v69
    v_dot2c_f32_bf16 v61, s17, v201
    v_dot2c_f32_bf16 v52, s18, v190
    v_dot2c_f32_bf16 v53, s18, v186
    v_dot2c_f32_bf16 v54, s18, v182
    v_dot2c_f32_bf16 v55, s18, v187
    v_dot2c_f32_bf16 v56, s18, v183
    v_dot2c_f32_bf16 v57, s18, v188
    v_dot2c_f32_bf16 v58, s18, v184
    v_dot2c_f32_bf16 v59, s18, v189
    v_dot2c_f32_bf16 v60, s18, v185
    v_dot2c_f32_bf16 v61, s18, v191
    v_dot2c_f32_bf16 v52, s19, v180
    v_dot2c_f32_bf16 v53, s19, v176
    v_dot2c_f32_bf16 v54, s19, v172
    v_dot2c_f32_bf16 v55, s19, v177
    v_dot2c_f32_bf16 v56, s19, v173
    v_dot2c_f32_bf16 v57, s19, v178
    v_dot2c_f32_bf16 v58, s19, v174
    v_dot2c_f32_bf16 v59, s19, v179
    v_dot2c_f32_bf16 v60, s19, v175
    v_dot2c_f32_bf16 v61, s19, v181
    s_waitcnt vmcnt(1)
    v_dot2c_f32_bf16 v32, v92, v83
    v_dot2c_f32_bf16 v33, v92, v70
    v_dot2c_f32_bf16 v34, v93, v83
    v_dot2c_f32_bf16 v35, v93, v70
    v_dot2c_f32_bf16 v36, v94, v83
    v_dot2c_f32_bf16 v37, v94, v70
    v_dot2c_f32_bf16 v38, v95, v83
    v_dot2c_f32_bf16 v39, v95, v70
    v_permlane32_swap_b32 v32, v36
    v_permlane32_swap_b32 v33, v37
    v_permlane32_swap_b32 v34, v38
    v_permlane32_swap_b32 v35, v39
    v_pk_add_f32 v[32:33], v[32:33], v[36:37]
    v_pk_add_f32 v[34:35], v[34:35], v[38:39]
    s_nop 1
    v_permlane16_swap_b32 v32, v34
    v_permlane16_swap_b32 v33, v35
    v_pk_add_f32 v[32:33], v[32:33], v[34:35]
    s_nop 1
    v_add_f32_dpp v34, v32, v32 row_ror:8 row_mask:0xf bank_mask:0x3
    s_nop 1
    v_add_f32_dpp v34, v33, v33 row_ror:8 row_mask:0xf bank_mask:0xc
    v_mul_f32 v9, s29, v34
    ds_write_b32 v10, v9 offset:48960
    s_waitcnt lgkmcnt(0)
    s_barrier
    ds_read_b32 v9, v11 offset:48960
    s_waitcnt lgkmcnt(0)
    v_add_f32_dpp v9, v9, v9 quad_perm:[1,0,3,2] row_mask:0xf bank_mask:0xf
    s_nop 1
    v_add_f32_dpp v9, v9, v9 quad_perm:[2,3,0,1] row_mask:0xf bank_mask:0xf
    s_nop 1
    v_add_f32_dpp v9, v9, v9 row_half_mirror row_mask:0xf bank_mask:0xf
    s_nop 1
    v_mov_b32_dpp v14, v9 row_ror:8 row_mask:0xf bank_mask:0xf
    v_cvt_pk_bf16_f32 v9, v9, v14
    s_nop 0
    v_readlane_b32 s16, v9, 0
    v_readlane_b32 s17, v9, 16
    v_readlane_b32 s18, v9, 32
    v_readlane_b32 s19, v9, 48
    v_dot2c_f32_bf16 v52, s16, v170
    v_dot2c_f32_bf16 v53, s16, v166
    v_dot2c_f32_bf16 v54, s16, v162
    v_dot2c_f32_bf16 v55, s16, v167
    v_dot2c_f32_bf16 v56, s16, v163
    v_dot2c_f32_bf16 v57, s16, v168
    v_dot2c_f32_bf16 v58, s16, v164
    v_dot2c_f32_bf16 v59, s16, v169
    v_dot2c_f32_bf16 v60, s16, v165
    v_dot2c_f32_bf16 v61, s16, v171
    v_dot2c_f32_bf16 v52, s17, v160
    v_dot2c_f32_bf16 v53, s17, v156
    v_dot2c_f32_bf16 v54, s17, v152
    v_dot2c_f32_bf16 v55, s17, v157
    v_dot2c_f32_bf16 v56, s17, v153
    v_dot2c_f32_bf16 v57, s17, v158
    v_dot2c_f32_bf16 v58, s17, v154
    v_dot2c_f32_bf16 v59, s17, v159
    v_dot2c_f32_bf16 v60, s17, v155
    v_dot2c_f32_bf16 v61, s17, v161
    v_dot2c_f32_bf16 v52, s18, v150
    v_dot2c_f32_bf16 v53, s18, v146
    v_dot2c_f32_bf16 v54, s18, v142
    v_dot2c_f32_bf16 v55, s18, v147
    v_dot2c_f32_bf16 v56, s18, v143
    v_dot2c_f32_bf16 v57, s18, v148
    v_dot2c_f32_bf16 v58, s18, v144
    v_dot2c_f32_bf16 v59, s18, v149
    v_dot2c_f32_bf16 v60, s18, v145
    v_dot2c_f32_bf16 v61, s18, v151
    v_dot2c_f32_bf16 v52, s19, v140
    v_dot2c_f32_bf16 v53, s19, v136
    v_dot2c_f32_bf16 v54, s19, v132
    v_dot2c_f32_bf16 v55, s19, v137
    v_dot2c_f32_bf16 v56, s19, v133
    v_dot2c_f32_bf16 v57, s19, v138
    v_dot2c_f32_bf16 v58, s19, v134
    v_dot2c_f32_bf16 v59, s19, v139
    v_dot2c_f32_bf16 v60, s19, v135
    v_dot2c_f32_bf16 v61, s19, v141
    ds_write_b128 v12, v[52:55] offset:2560
    ds_write_b128 v12, v[56:59] offset:2576
    s_nop 0
    ds_write_b64 v6, v[60:61] offset:4608
    s_mov_b64 exec, 0xfffff
    s_waitcnt lgkmcnt(0)
    s_barrier
    ds_read_b128 v[84:87], v13 offset:2560
    ds_read_b128 v[88:91], v13 offset:7680
    ds_read_b128 v[92:95], v13 offset:12800
    ds_read_b128 v[96:99], v13 offset:17920
    ds_read_b128 v[100:103], v13 offset:23040
    ds_read_b128 v[104:107], v13 offset:28160
    ds_read_b128 v[108:111], v13 offset:33280
    ds_read_b128 v[112:115], v13 offset:38400
    s_waitcnt lgkmcnt(6)
    v_pk_add_f32 v[84:85], v[84:85], v[88:89]
    v_pk_add_f32 v[86:87], v[86:87], v[90:91]
    s_waitcnt lgkmcnt(5)
    v_pk_add_f32 v[84:85], v[84:85], v[92:93]
    v_pk_add_f32 v[86:87], v[86:87], v[94:95]
    s_waitcnt lgkmcnt(4)
    v_pk_add_f32 v[84:85], v[84:85], v[96:97]
    v_pk_add_f32 v[86:87], v[86:87], v[98:99]
    s_waitcnt lgkmcnt(3)
    v_pk_add_f32 v[84:85], v[84:85], v[100:101]
    v_pk_add_f32 v[86:87], v[86:87], v[102:103]
    s_waitcnt lgkmcnt(2)
    v_pk_add_f32 v[84:85], v[84:85], v[104:105]
    v_pk_add_f32 v[86:87], v[86:87], v[106:107]
    s_waitcnt lgkmcnt(1)
    v_pk_add_f32 v[84:85], v[84:85], v[108:109]
    v_pk_add_f32 v[86:87], v[86:87], v[110:111]
    s_waitcnt lgkmcnt(0)
    v_pk_add_f32 v[84:85], v[84:85], v[112:113]
    v_pk_add_f32 v[86:87], v[86:87], v[114:115]
    v_mov_b32_sdwa v84, s75 dst_sel:BYTE_0 dst_unused:UNUSED_PRESERVE src0_sel:BYTE_0
    v_mov_b32_sdwa v85, s75 dst_sel:BYTE_0 dst_unused:UNUSED_PRESERVE src0_sel:BYTE_1
    v_mov_b32_sdwa v86, s75 dst_sel:BYTE_0 dst_unused:UNUSED_PRESERVE src0_sel:BYTE_2
    v_mov_b32_sdwa v87, s75 dst_sel:BYTE_0 dst_unused:UNUSED_PRESERVE src0_sel:BYTE_3
    s_nop 0
    buffer_store_dwordx4 v[84:87], v13, s[76:79], s11 offen offset:2560 sc1
    s_mov_b64 exec, -1
    s_cmp_eq_u32 s100, 0
    s_cbranch_scc1 LA_fin
    buffer_load_dwordx4 v[116:119], v0, s[76:79], s22 offen sc1
    buffer_load_dwordx4 v[120:123], v0, s[76:79], s5 offen sc1
    ds_read_b128 v[16:19], v8 offset:40960
    ds_read_b128 v[20:23], v8 offset:40976
    v_and_b32 v254, s13, v255
    v_lshlrev_b32 v255, 16, v255
    s_waitcnt lgkmcnt(0)
    v_pk_add_f32 v[16:17], v[16:17], v[20:21]
    v_pk_add_f32 v[18:19], v[18:19], v[22:23]
    v_pk_add_f32 v[16:17], v[16:17], v[18:19]
    v_add_f32 v16, v16, v17
    v_cvt_pk_bf16_f32 v16, v16, v16
    v_and_b32 v16, s13, v16
    v_add_f32 v16, v16, v255
    v_cvt_pk_bf16_f32 v16, v16, v16
    v_and_b32 v16, s13, v16
    v_mul_f32 v9, s15, v16
    v_exp_f32 v9, -v9
    s_nop 0
    v_add_f32 v9, 1.0, v9
    v_rcp_f32 v9, v9
    s_nop 0
    v_mul_f32 v16, v16, v9
    v_cvt_pk_bf16_f32 v16, v16, v16
    v_and_b32 v16, s13, v16
Lpoll:
    s_waitcnt vmcnt(1)
    v_perm_b32 v9, v117, v116, s72
    v_perm_b32 v10, v119, v118, s72
    v_lshl_or_b32 v9, v10, 16, v9
    v_cmp_ne_u32 vcc, s75, v9
    s_nop 0
    s_and_b64 s[80:81], vcc, s[24:25]
    s_waitcnt vmcnt(0)
    v_perm_b32 v9, v121, v120, s72
    v_perm_b32 v10, v123, v122, s72
    v_lshl_or_b32 v9, v10, 16, v9
    v_cmp_ne_u32 vcc, s75, v9
    s_nop 0
    s_and_b64 vcc, vcc, s[30:31]
    s_or_b64 exec, vcc, s[80:81]
    s_cbranch_scc0 Lpoll_done
    s_sub_u32 s101, s101, 1
    s_cbranch_scc1 Lpoll_done
    buffer_load_dwordx4 v[116:119], v0, s[76:79], s22 offen sc1
    buffer_load_dwordx4 v[120:123], v0, s[76:79], s5 offen sc1
    s_branch Lpoll
Lpoll_done:
    s_mov_b64 exec, -1
    v_and_b32 v116, s73, v116
    v_and_b32 v117, s73, v117
    v_and_b32 v118, s73, v118
    v_and_b32 v119, s73, v119
    v_and_b32 v120, s73, v120
    v_and_b32 v121, s73, v121
    v_and_b32 v122, s73, v122
    v_and_b32 v123, s73, v123
    v_pk_add_f32 v[116:117], v[116:117], v[120:121]
    v_pk_add_f32 v[118:119], v[118:119], v[122:123]
    s_nop 1
    v_permlane32_swap_b32 v116, v118
    v_permlane32_swap_b32 v117, v119
    v_pk_add_f32 v[116:117], v[116:117], v[118:119]
    s_nop 1
    v_permlane16_swap_b32 v116, v117
    v_add_f32 v116, v116, v117
    s_nop 1
    v_add_f32_dpp v116, v116, v116 row_ror:8 row_mask:0xf bank_mask:0xf
    s_nop 1
    v_add_f32_dpp v116, v116, v116 row_ror:4 row_mask:0xf bank_mask:0xf
    ds_write_b32 v15, v116 offset:41472
    s_cmp_lg_u32 s3, 0
    s_waitcnt lgkmcnt(0)
    s_barrier
    s_cbranch_scc1 LA_fin
    ds_read_b128 v[116:119], v8 offset:41472
    ds_read_b128 v[120:123], v8 offset:41488
    s_waitcnt lgkmcnt(0)
    v_pk_add_f32 v[116:117], v[116:117], v[120:121]
    v_pk_add_f32 v[118:119], v[118:119], v[122:123]
    v_pk_add_f32 v[116:117], v[116:117], v[118:119]
    v_add_f32 v116, v116, v117
    v_cvt_pk_bf16_f32 v116, v116, v116
    v_and_b32 v116, s13, v116
    v_mul_f32 v116, v116, v16
    v_cvt_pk_bf16_f32 v116, v116, v116
    v_and_b32 v116, s13, v116
    v_add_f32 v116, v116, v254
    v_cvt_pk_bf16_f32 v116, v116, v116
    s_mov_b64 exec, 0xffff
    buffer_store_short v116, v3, s[64:67], s23 offen
    s_cmp_lg_u32 s2, 0
    s_cbranch_scc1 LA_fin
    v_mov_b32 v9, s75
    s_mov_b64 exec, 1
    buffer_store_dword v9, off, s[76:79], 0 offset:0 sc1
LA_fin:
LA_done:
    s_endpgm
Lpx_far:
    buffer_store_dwordx4 v[16:19], v10, s[76:79], s81 offen sc1
    s_branch Lpx_back
Lq_slow:
    s_mov_b32 s101, 200000
Lq_loop:
    s_nop 4
    s_and_b32 s80, s101, 15
    s_cmp_lg_u32 s80, 1
    s_cbranch_scc1 Lq_nowb
    buffer_wbl2 sc1
    s_waitcnt vmcnt(0)
Lq_nowb:
    buffer_load_dwordx4 v[40:43], v46, s[76:79], 0 offen sc1
    s_waitcnt vmcnt(0)
    v_perm_b32 v9, v41, v40, s72
    v_perm_b32 v10, v43, v42, s72
    v_lshl_or_b32 v9, v10, 16, v9
    v_cmp_ne_u32 vcc, s75, v9
    s_nop 0
    s_cmp_lg_u64 vcc, 0
    s_cbranch_scc0 Lq_ok
    s_sub_u32 s101, s101, 1
    s_cbranch_scc0 Lq_loop
    s_branch Lq_ok
Lm_slow:
    s_mov_b32 s101, 200000
Lm_loop:
    s_nop 4
    s_and_b32 s80, s101, 15
    s_cmp_lg_u32 s80, 1
    s_cbranch_scc1 Lm_nowb
    buffer_wbl2 sc1
    s_waitcnt vmcnt(0)
Lm_nowb:
    buffer_load_dwordx4 v[52:55], v56, s[76:79], 0 offen sc1
    s_waitcnt vmcnt(0)
    v_xor_b32 v9, s75, v55
    v_cmp_ne_u32 vcc, s75, v53
    v_cmp_lt_u32 s[80:81], 15, v9
    s_nop 0
    s_or_b64 vcc, vcc, s[80:81]
    s_cbranch_scc0 Lm_ok
    s_sub_u32 s101, s101, 1
    s_cbranch_scc0 Lm_loop
    s_branch Lm_ok
Lm_far:
    buffer_wbl2 sc1
    s_waitcnt vmcnt(0)
    s_branch Lm_back
Lg_slow:
    s_cmp_eq_u32 s100, 0
    s_cbranch_scc1 Lg_ok
    s_mov_b32 s101, 200000
Lg_loop:
    s_nop 4
    buffer_load_dwordx4 v[56:59], v60, s[76:79], 0 offen sc1
    s_waitcnt vmcnt(0)
    v_perm_b32 v9, v57, v56, s72
    v_perm_b32 v14, v59, v58, s72
    v_lshl_or_b32 v9, v14, 16, v9
    v_cmp_ne_u32 vcc, s75, v9
    s_nop 0
    s_and_b64 vcc, vcc, 0xfff
    s_cbranch_scc0 Lg_ok
    s_sub_u32 s101, s101, 1
    s_cbranch_scc0 Lg_loop
    s_branch Lg_ok
Lxs_far:
    buffer_store_dwordx4 v[40:43], v4, s[76:79], s81 offen sc1
    s_branch Lxs_back
Lx_slow:
    s_mov_b32 s101, 200000
Lx_loop:
    s_nop 4
    s_mov_b32 exec_hi, 0xffff
    buffer_load_dwordx4 v[52:55], v4, s[76:79], s27 offen sc1
    s_mov_b32 exec_hi, -1
    s_waitcnt vmcnt(0)
    v_perm_b32 v9, v53, v52, s72
    v_perm_b32 v14, v55, v54, s72
    v_lshl_or_b32 v9, v14, 16, v9
    v_cmp_ne_u32 vcc, s75, v9
    s_nop 0
    s_and_b32 vcc_hi, vcc_hi, 0xffff
    s_cmp_lg_u64 vcc, 0
    s_cbranch_scc0 Lx_ok
    s_sub_u32 s101, s101, 1
    s_cbranch_scc0 Lx_loop
    s_branch Lx_ok
    s_endpgm
.section .rodata,"a"
.p2align 6
.amdhsa_kernel recurrent_scan__gqa_block_cached__dense_activation_squared_relu__decode_kernel
  .amdhsa_next_free_vgpr 256
  .amdhsa_next_free_sgpr 102
  .amdhsa_accum_offset 256
  .amdhsa_group_segment_fixed_size 0
  .amdhsa_kernarg_size 104
  .amdhsa_user_sgpr_count 2
  .amdhsa_user_sgpr_kernarg_segment_ptr 1
  .amdhsa_system_sgpr_workgroup_id_x 1
  .amdhsa_float_denorm_mode_32 3
.end_amdhsa_kernel
```
